```python
import torch

def _softmax(x, axis=-1):
    return torch.softmax(x, dim=axis)
def _gelu(x):
    return torch.nn.functional.gelu(x, approximate="tanh")
def _silu(x):
    return torch.nn.functional.silu(x)
def _sigmoid(x):
    return torch.sigmoid(x)
def _layernorm(x, axis=-1, eps=1e-5):
    m = x.mean(dim=axis, keepdim=True)
    v = x.var(dim=axis, keepdim=True, unbiased=False)
    return (x - m) / torch.sqrt(v + eps)
def _scatter_add(tgt, idx, src, axis=0):
    return tgt.clone().index_add_(axis, idx, src)
def _segment_sum(src, seg, n):
    out = torch.zeros((n,) + src.shape[1:], dtype=src.dtype)
    return out.index_add_(0, seg, src)
def _pad(x, pw):
    flat = tuple(v for pair in reversed(pw) for v in pair)
    return torch.nn.functional.pad(x, flat)

kernel_name = 'parallel_sum__compressed_kv_cla__dense_activation_gelu__decode'

def setup_inputs():

    _w = (lambda a: (lambda t: t.to(torch.bfloat16) if t.is_floating_point() else t)(torch.as_tensor(a)))
    def _A_setup():
        B, H, Sq, Sk, D, M = 2, 16, 1, 4096, 256, 448
        Dc = 4 * D
        return {
            "x": _w((lambda *s: torch.randn(*s, dtype=torch.bfloat16) * 0.05)(B, Sq, M)),
            "c_kv": _w((lambda *s: torch.randn(*s, dtype=torch.bfloat16) * 0.8)(B, Sk, Dc)),
            "w_q": _w((lambda *s: torch.randn(*s, dtype=torch.bfloat16) * 3.2)(M, H, D) * (M ** -0.5)),
            "w_uk": _w((lambda *s: torch.randn(*s, dtype=torch.bfloat16) * 3.2)(Dc, H, D) * (Dc ** -0.5)),
            "w_uv": _w((lambda *s: torch.randn(*s, dtype=torch.bfloat16) * 0.8)(Dc, H, D) * (Dc ** -0.5)),
            "w_o": _w((lambda *s: torch.randn(*s, dtype=torch.bfloat16) * 0.8)(H, D, M) * ((H * D) ** -0.5)),
        }
    _A_in = _A_setup()

    def _B_setup():
        B, S, D, F = 2, 1, 448, 1792
        return {
            "x": _w((lambda *s: torch.randn(*s, dtype=torch.bfloat16) * 0.05)(B, S, D)),
            "w1": _w((lambda *s: torch.randn(*s, dtype=torch.bfloat16) * 1.6)(D, F) * (D ** -0.5)),
            "b1": _w((lambda *s: torch.randn(*s, dtype=torch.bfloat16) * 1.6)(F) * 0.01),
            "w2": _w((lambda *s: torch.randn(*s, dtype=torch.bfloat16) * 0.2)(F, D) * (F ** -0.5)),
            "b2": _w((lambda *s: torch.randn(*s, dtype=torch.bfloat16) * 0.2)(D) * 0.01),
        }
    _B_in = _B_setup()

    return {
        "A_x": _A_in["x"],
        "A_c_kv": _A_in["c_kv"],
        "A_w_q": _A_in["w_q"],
        "A_w_uk": _A_in["w_uk"],
        "A_w_uv": _A_in["w_uv"],
        "A_w_o": _A_in["w_o"],
        "B_x": _B_in["x"],
        "B_w1": _B_in["w1"],
        "B_b1": _B_in["b1"],
        "B_w2": _B_in["w2"],
        "B_b2": _B_in["b2"],
    }

def reference(A_x, A_c_kv, A_w_q, A_w_uk, A_w_uv, A_w_o, B_x, B_w1, B_b1, B_w2, B_b2):
    def _A_ref(x, c_kv, w_q, w_uk, w_uv, w_o):
        B, Sq, M = x.shape[0], x.shape[1], x.shape[2]
        Sk = c_kv.shape[1]
        H, D = w_q.shape[1], w_q.shape[2]
        q = torch.einsum("bqm,mhd->bhqd", x, w_q)
        k = torch.einsum("bkc,chd->bhkd", c_kv, w_uk)
        v = torch.einsum("bkc,chd->bhkd", c_kv, w_uv)
        scores = torch.einsum("bhqd,bhkd->bhqk", q, k) * (D ** -0.5)
        off = Sk - Sq
        qi = torch.arange(Sq)[:, None]
        kj = torch.arange(Sk)[None, :]
        cmask = kj <= (qi + off)
        scores = torch.where(cmask[None, None], scores, -1e9)
        p = _softmax(scores, axis=-1)
        ctx = torch.einsum("bhqk,bhkd->bhqd", p, v)
        return torch.einsum("bhqd,hdm->bqm", ctx, w_o)

    def _B_ref(x, w1, b1, w2, b2):
        h = torch.einsum("bsd,df->bsf", x, w1) + b1
        h = _gelu(h)
        return torch.einsum("bsf,fd->bsd", h, w2) + b2

    x = A_x
    xn = _layernorm(x, axis=-1)
    return x + _A_ref(xn, A_c_kv, A_w_q, A_w_uk, A_w_uv, A_w_o) + _B_ref(xn, B_w1, B_b1, B_w2, B_b2)
```

```asm
; @launch kernel=ka_kernel grid=(270,1,1) block=(512,1,1) lds=49152
; @launch kernel=kb_kernel grid=(284,1,1) block=(256,1,1) lds=74240
; @launch kernel=kc_kernel grid=(256,1,1) block=(512,1,1) lds=40960
; @launch kernel=kd_kernel grid=(28,1,1) block=(256,1,1) lds=1024
.amdgcn_target "amdgcn-amd-amdhsa--gfx950"
.text
.globl ka_kernel
.p2align 8
.type ka_kernel,@function
ka_kernel:
s_cmp_ge_u32 s2, 270
s_cbranch_scc1 ka_kernel_end
s_load_dwordx16 s[16:31], s[0:1], 0
s_load_dwordx8 s[32:39], s[0:1], 64
s_load_dwordx2 s[40:41], s[0:1], 104
s_waitcnt lgkmcnt(0)
v_mov_b32 v6, 0
v_mov_b32 v7, 0
v_and_b32 v1, 63, v0
v_lshrrev_b32 v2, 6, v0
s_nop 0
v_readfirstlane_b32 s3, v2
s_cmp_ge_u32 s2, 256
s_cbranch_scc1 ka_ffn_ld
s_and_b32 s4, s2, 7
s_lshl_b32 s4, s4, 1
s_bfe_u32 s5, s2, 0x10003
s_add_u32 s4, s4, s5
s_lshr_b32 s5, s2, 4
v_and_b32 v3, 31, v0
v_lshrrev_b32 v4, 5, v0
v_lshlrev_b32 v5, 13, v4
v_lshl_add_u32 v5, v3, 4, v5
s_lshl_b32 s6, s4, 9
v_add_u32 v5, s6, v5
s_and_b32 s7, s3, 3
s_lshl_b32 s7, s7, 4
s_lshl_b32 s8, s5, 6
s_add_u32 s7, s7, s8
v_and_b32 v6, 15, v1
v_add_u32 v6, s7, v6
v_lshlrev_b32 v6, 13, v6
v_lshrrev_b32 v7, 4, v1
v_lshl_add_u32 v6, v7, 4, v6
v_add_u32 v6, s6, v6
global_load_dwordx4 v[96:99], v6, s[22:23] offset:0
global_load_dwordx4 v[100:103], v6, s[22:23] offset:64
global_load_dwordx4 v[104:107], v6, s[22:23] offset:128
global_load_dwordx4 v[108:111], v6, s[22:23] offset:192
global_load_dwordx4 v[112:115], v6, s[22:23] offset:256
global_load_dwordx4 v[116:119], v6, s[22:23] offset:320
global_load_dwordx4 v[120:123], v6, s[22:23] offset:384
global_load_dwordx4 v[124:127], v6, s[22:23] offset:448
global_load_dwordx4 v[64:67], v5, s[20:21]
v_add_u32 v5, 131072, v5
global_load_dwordx4 v[68:71], v5, s[20:21]
v_add_u32 v5, 131072, v5
global_load_dwordx4 v[72:75], v5, s[20:21]
v_add_u32 v5, 131072, v5
global_load_dwordx4 v[76:79], v5, s[20:21]
v_add_u32 v5, 131072, v5
global_load_dwordx4 v[80:83], v5, s[20:21]
v_add_u32 v5, 131072, v5
global_load_dwordx4 v[84:87], v5, s[20:21]
v_add_u32 v5, 131072, v5
global_load_dwordx4 v[88:91], v5, s[20:21]
v_add_u32 v5, 131072, v5
global_load_dwordx4 v[92:95], v5, s[20:21]
v_add_u32 v5, 131072, v5
s_branch ka_ln
ka_ffn_ld:
s_sub_u32 s4, s2, 256
v_and_b32 v3, 15, v0
v_lshrrev_b32 v4, 4, v0
v_mul_u32_u24 v5, 3584, v4
v_lshl_add_u32 v5, v3, 4, v5
s_lshl_b32 s6, s4, 8
v_add_u32 v5, s6, v5
global_load_dwordx4 v[64:67], v5, s[30:31]
v_add_u32 v5, 114688, v5
global_load_dwordx4 v[68:71], v5, s[30:31]
v_add_u32 v5, 114688, v5
global_load_dwordx4 v[72:75], v5, s[30:31]
v_add_u32 v5, 114688, v5
global_load_dwordx4 v[76:79], v5, s[30:31]
v_add_u32 v5, 114688, v5
global_load_dwordx4 v[80:83], v5, s[30:31]
v_add_u32 v5, 114688, v5
global_load_dwordx4 v[84:87], v5, s[30:31]
v_add_u32 v5, 114688, v5
global_load_dwordx4 v[88:91], v5, s[30:31]
v_add_u32 v5, 114688, v5
global_load_dwordx4 v[92:95], v5, s[30:31]
v_add_u32 v5, 114688, v5
global_load_dwordx4 v[96:99], v5, s[30:31]
v_add_u32 v5, 114688, v5
global_load_dwordx4 v[100:103], v5, s[30:31]
v_add_u32 v5, 114688, v5
global_load_dwordx4 v[104:107], v5, s[30:31]
v_add_u32 v5, 114688, v5
global_load_dwordx4 v[108:111], v5, s[30:31]
v_add_u32 v5, 114688, v5
global_load_dwordx4 v[112:115], v5, s[30:31]
v_add_u32 v5, 114688, v5
global_load_dwordx4 v[116:119], v5, s[30:31]
ka_ln:
v_mov_b32 v8, 0
v_mov_b32 v9, 0
v_mov_b32 v10, 0
v_mov_b32 v11, 0
v_lshlrev_b32 v12, 4, v0
ds_write_b128 v12, v[8:11] offset:40960
s_cmp_lg_u32 s3, 0
s_cbranch_scc1 ka_lnd
v_lshlrev_b32 v12, 1, v1
global_load_ushort v20, v12, s[16:17] offset:0
global_load_ushort v21, v12, s[16:17] offset:128
global_load_ushort v22, v12, s[16:17] offset:256
global_load_ushort v23, v12, s[16:17] offset:384
global_load_ushort v24, v12, s[16:17] offset:512
global_load_ushort v25, v12, s[16:17] offset:640
global_load_ushort v26, v12, s[16:17] offset:768
global_load_ushort v27, v12, s[16:17] offset:896
global_load_ushort v28, v12, s[16:17] offset:1024
global_load_ushort v29, v12, s[16:17] offset:1152
global_load_ushort v30, v12, s[16:17] offset:1280
global_load_ushort v31, v12, s[16:17] offset:1408
global_load_ushort v32, v12, s[16:17] offset:1536
global_load_ushort v33, v12, s[16:17] offset:1664
s_waitcnt vmcnt(0)
v_lshlrev_b32 v20, 16, v20
v_lshlrev_b32 v21, 16, v21
v_lshlrev_b32 v22, 16, v22
v_lshlrev_b32 v23, 16, v23
v_lshlrev_b32 v24, 16, v24
v_lshlrev_b32 v25, 16, v25
v_lshlrev_b32 v26, 16, v26
v_add_f32 v13, v20, v21
v_add_f32 v13, v13, v22
v_add_f32 v13, v13, v23
v_add_f32 v13, v13, v24
v_add_f32 v13, v13, v25
v_add_f32 v13, v13, v26
v_xor_b32 v14, 1, v1
v_lshlrev_b32 v14, 2, v14
ds_bpermute_b32 v14, v14, v13
s_waitcnt lgkmcnt(0)
v_add_f32 v13, v13, v14
v_xor_b32 v14, 2, v1
v_lshlrev_b32 v14, 2, v14
ds_bpermute_b32 v14, v14, v13
s_waitcnt lgkmcnt(0)
v_add_f32 v13, v13, v14
v_xor_b32 v14, 4, v1
v_lshlrev_b32 v14, 2, v14
ds_bpermute_b32 v14, v14, v13
s_waitcnt lgkmcnt(0)
v_add_f32 v13, v13, v14
v_xor_b32 v14, 8, v1
v_lshlrev_b32 v14, 2, v14
ds_bpermute_b32 v14, v14, v13
s_waitcnt lgkmcnt(0)
v_add_f32 v13, v13, v14
v_xor_b32 v14, 16, v1
v_lshlrev_b32 v14, 2, v14
ds_bpermute_b32 v14, v14, v13
s_waitcnt lgkmcnt(0)
v_add_f32 v13, v13, v14
v_xor_b32 v14, 32, v1
v_lshlrev_b32 v14, 2, v14
ds_bpermute_b32 v14, v14, v13
s_waitcnt lgkmcnt(0)
v_add_f32 v13, v13, v14
v_mul_f32 v13, 0x3b124925, v13
v_mov_b32 v15, 0
v_sub_f32 v14, v20, v13
v_fmac_f32 v15, v14, v14
v_sub_f32 v14, v21, v13
v_fmac_f32 v15, v14, v14
v_sub_f32 v14, v22, v13
v_fmac_f32 v15, v14, v14
v_sub_f32 v14, v23, v13
v_fmac_f32 v15, v14, v14
v_sub_f32 v14, v24, v13
v_fmac_f32 v15, v14, v14
v_sub_f32 v14, v25, v13
v_fmac_f32 v15, v14, v14
v_sub_f32 v14, v26, v13
v_fmac_f32 v15, v14, v14
v_xor_b32 v14, 1, v1
v_lshlrev_b32 v14, 2, v14
ds_bpermute_b32 v14, v14, v15
s_waitcnt lgkmcnt(0)
v_add_f32 v15, v15, v14
v_xor_b32 v14, 2, v1
v_lshlrev_b32 v14, 2, v14
ds_bpermute_b32 v14, v14, v15
s_waitcnt lgkmcnt(0)
v_add_f32 v15, v15, v14
v_xor_b32 v14, 4, v1
v_lshlrev_b32 v14, 2, v14
ds_bpermute_b32 v14, v14, v15
s_waitcnt lgkmcnt(0)
v_add_f32 v15, v15, v14
v_xor_b32 v14, 8, v1
v_lshlrev_b32 v14, 2, v14
ds_bpermute_b32 v14, v14, v15
s_waitcnt lgkmcnt(0)
v_add_f32 v15, v15, v14
v_xor_b32 v14, 16, v1
v_lshlrev_b32 v14, 2, v14
ds_bpermute_b32 v14, v14, v15
s_waitcnt lgkmcnt(0)
v_add_f32 v15, v15, v14
v_xor_b32 v14, 32, v1
v_lshlrev_b32 v14, 2, v14
ds_bpermute_b32 v14, v14, v15
s_waitcnt lgkmcnt(0)
v_add_f32 v15, v15, v14
v_mul_f32 v15, 0x3b124925, v15
v_cvt_pk_bf16_f32 v14, v13, v13
v_lshlrev_b32 v13, 16, v14
v_cvt_pk_bf16_f32 v14, v15, v15
v_lshlrev_b32 v15, 16, v14
v_add_f32 v15, 0x3727c5ac, v15
v_cvt_pk_bf16_f32 v14, v15, v15
v_lshlrev_b32 v15, 16, v14
v_sqrt_f32 v15, v15
s_nop 0
v_cvt_pk_bf16_f32 v14, v15, v15
v_lshlrev_b32 v15, 16, v14
v_rcp_f32 v15, v15
s_nop 0
v_sub_f32 v20, v20, v13
v_cvt_pk_bf16_f32 v14, v20, v20
v_lshlrev_b32 v20, 16, v14
v_mul_f32 v20, v20, v15
v_cvt_pk_bf16_f32 v14, v20, v20
v_lshlrev_b32 v20, 16, v14
v_sub_f32 v21, v21, v13
v_cvt_pk_bf16_f32 v14, v21, v21
v_lshlrev_b32 v21, 16, v14
v_mul_f32 v21, v21, v15
v_cvt_pk_bf16_f32 v14, v21, v21
v_lshlrev_b32 v21, 16, v14
v_sub_f32 v22, v22, v13
v_cvt_pk_bf16_f32 v14, v22, v22
v_lshlrev_b32 v22, 16, v14
v_mul_f32 v22, v22, v15
v_cvt_pk_bf16_f32 v14, v22, v22
v_lshlrev_b32 v22, 16, v14
v_sub_f32 v23, v23, v13
v_cvt_pk_bf16_f32 v14, v23, v23
v_lshlrev_b32 v23, 16, v14
v_mul_f32 v23, v23, v15
v_cvt_pk_bf16_f32 v14, v23, v23
v_lshlrev_b32 v23, 16, v14
v_sub_f32 v24, v24, v13
v_cvt_pk_bf16_f32 v14, v24, v24
v_lshlrev_b32 v24, 16, v14
v_mul_f32 v24, v24, v15
v_cvt_pk_bf16_f32 v14, v24, v24
v_lshlrev_b32 v24, 16, v14
v_sub_f32 v25, v25, v13
v_cvt_pk_bf16_f32 v14, v25, v25
v_lshlrev_b32 v25, 16, v14
v_mul_f32 v25, v25, v15
v_cvt_pk_bf16_f32 v14, v25, v25
v_lshlrev_b32 v25, 16, v14
v_sub_f32 v26, v26, v13
v_cvt_pk_bf16_f32 v14, v26, v26
v_lshlrev_b32 v26, 16, v14
v_mul_f32 v26, v26, v15
v_cvt_pk_bf16_f32 v14, v26, v26
v_lshlrev_b32 v26, 16, v14
v_lshlrev_b32 v14, 3, v1
ds_write_b32 v14, v20 offset:0
ds_write_b32 v14, v21 offset:512
ds_write_b32 v14, v22 offset:1024
ds_write_b32 v14, v23 offset:1536
ds_write_b32 v14, v24 offset:2048
ds_write_b32 v14, v25 offset:2560
ds_write_b32 v14, v26 offset:3072
v_lshlrev_b32 v27, 16, v27
v_lshlrev_b32 v28, 16, v28
v_lshlrev_b32 v29, 16, v29
v_lshlrev_b32 v30, 16, v30
v_lshlrev_b32 v31, 16, v31
v_lshlrev_b32 v32, 16, v32
v_lshlrev_b32 v33, 16, v33
v_add_f32 v13, v27, v28
v_add_f32 v13, v13, v29
v_add_f32 v13, v13, v30
v_add_f32 v13, v13, v31
v_add_f32 v13, v13, v32
v_add_f32 v13, v13, v33
v_xor_b32 v14, 1, v1
v_lshlrev_b32 v14, 2, v14
ds_bpermute_b32 v14, v14, v13
s_waitcnt lgkmcnt(0)
v_add_f32 v13, v13, v14
v_xor_b32 v14, 2, v1
v_lshlrev_b32 v14, 2, v14
ds_bpermute_b32 v14, v14, v13
s_waitcnt lgkmcnt(0)
v_add_f32 v13, v13, v14
v_xor_b32 v14, 4, v1
v_lshlrev_b32 v14, 2, v14
ds_bpermute_b32 v14, v14, v13
s_waitcnt lgkmcnt(0)
v_add_f32 v13, v13, v14
v_xor_b32 v14, 8, v1
v_lshlrev_b32 v14, 2, v14
ds_bpermute_b32 v14, v14, v13
s_waitcnt lgkmcnt(0)
v_add_f32 v13, v13, v14
v_xor_b32 v14, 16, v1
v_lshlrev_b32 v14, 2, v14
ds_bpermute_b32 v14, v14, v13
s_waitcnt lgkmcnt(0)
v_add_f32 v13, v13, v14
v_xor_b32 v14, 32, v1
v_lshlrev_b32 v14, 2, v14
ds_bpermute_b32 v14, v14, v13
s_waitcnt lgkmcnt(0)
v_add_f32 v13, v13, v14
v_mul_f32 v13, 0x3b124925, v13
v_mov_b32 v15, 0
v_sub_f32 v14, v27, v13
v_fmac_f32 v15, v14, v14
v_sub_f32 v14, v28, v13
v_fmac_f32 v15, v14, v14
v_sub_f32 v14, v29, v13
v_fmac_f32 v15, v14, v14
v_sub_f32 v14, v30, v13
v_fmac_f32 v15, v14, v14
v_sub_f32 v14, v31, v13
v_fmac_f32 v15, v14, v14
v_sub_f32 v14, v32, v13
v_fmac_f32 v15, v14, v14
v_sub_f32 v14, v33, v13
v_fmac_f32 v15, v14, v14
v_xor_b32 v14, 1, v1
v_lshlrev_b32 v14, 2, v14
ds_bpermute_b32 v14, v14, v15
s_waitcnt lgkmcnt(0)
v_add_f32 v15, v15, v14
v_xor_b32 v14, 2, v1
v_lshlrev_b32 v14, 2, v14
ds_bpermute_b32 v14, v14, v15
s_waitcnt lgkmcnt(0)
v_add_f32 v15, v15, v14
v_xor_b32 v14, 4, v1
v_lshlrev_b32 v14, 2, v14
ds_bpermute_b32 v14, v14, v15
s_waitcnt lgkmcnt(0)
v_add_f32 v15, v15, v14
v_xor_b32 v14, 8, v1
v_lshlrev_b32 v14, 2, v14
ds_bpermute_b32 v14, v14, v15
s_waitcnt lgkmcnt(0)
v_add_f32 v15, v15, v14
v_xor_b32 v14, 16, v1
v_lshlrev_b32 v14, 2, v14
ds_bpermute_b32 v14, v14, v15
s_waitcnt lgkmcnt(0)
v_add_f32 v15, v15, v14
v_xor_b32 v14, 32, v1
v_lshlrev_b32 v14, 2, v14
ds_bpermute_b32 v14, v14, v15
s_waitcnt lgkmcnt(0)
v_add_f32 v15, v15, v14
v_mul_f32 v15, 0x3b124925, v15
v_cvt_pk_bf16_f32 v14, v13, v13
v_lshlrev_b32 v13, 16, v14
v_cvt_pk_bf16_f32 v14, v15, v15
v_lshlrev_b32 v15, 16, v14
v_add_f32 v15, 0x3727c5ac, v15
v_cvt_pk_bf16_f32 v14, v15, v15
v_lshlrev_b32 v15, 16, v14
v_sqrt_f32 v15, v15
s_nop 0
v_cvt_pk_bf16_f32 v14, v15, v15
v_lshlrev_b32 v15, 16, v14
v_rcp_f32 v15, v15
s_nop 0
v_sub_f32 v27, v27, v13
v_cvt_pk_bf16_f32 v14, v27, v27
v_lshlrev_b32 v27, 16, v14
v_mul_f32 v27, v27, v15
v_cvt_pk_bf16_f32 v14, v27, v27
v_lshlrev_b32 v27, 16, v14
v_sub_f32 v28, v28, v13
v_cvt_pk_bf16_f32 v14, v28, v28
v_lshlrev_b32 v28, 16, v14
v_mul_f32 v28, v28, v15
v_cvt_pk_bf16_f32 v14, v28, v28
v_lshlrev_b32 v28, 16, v14
v_sub_f32 v29, v29, v13
v_cvt_pk_bf16_f32 v14, v29, v29
v_lshlrev_b32 v29, 16, v14
v_mul_f32 v29, v29, v15
v_cvt_pk_bf16_f32 v14, v29, v29
v_lshlrev_b32 v29, 16, v14
v_sub_f32 v30, v30, v13
v_cvt_pk_bf16_f32 v14, v30, v30
v_lshlrev_b32 v30, 16, v14
v_mul_f32 v30, v30, v15
v_cvt_pk_bf16_f32 v14, v30, v30
v_lshlrev_b32 v30, 16, v14
v_sub_f32 v31, v31, v13
v_cvt_pk_bf16_f32 v14, v31, v31
v_lshlrev_b32 v31, 16, v14
v_mul_f32 v31, v31, v15
v_cvt_pk_bf16_f32 v14, v31, v31
v_lshlrev_b32 v31, 16, v14
v_sub_f32 v32, v32, v13
v_cvt_pk_bf16_f32 v14, v32, v32
v_lshlrev_b32 v32, 16, v14
v_mul_f32 v32, v32, v15
v_cvt_pk_bf16_f32 v14, v32, v32
v_lshlrev_b32 v32, 16, v14
v_sub_f32 v33, v33, v13
v_cvt_pk_bf16_f32 v14, v33, v33
v_lshlrev_b32 v33, 16, v14
v_mul_f32 v33, v33, v15
v_cvt_pk_bf16_f32 v14, v33, v33
v_lshlrev_b32 v33, 16, v14
v_lshlrev_b32 v14, 3, v1
ds_write_b32 v14, v27 offset:4
ds_write_b32 v14, v28 offset:516
ds_write_b32 v14, v29 offset:1028
ds_write_b32 v14, v30 offset:1540
ds_write_b32 v14, v31 offset:2052
ds_write_b32 v14, v32 offset:2564
ds_write_b32 v14, v33 offset:3076
ka_lnd:
s_waitcnt lgkmcnt(0)
s_barrier
v_mov_b32 v40, 0
v_mov_b32 v41, 0
v_mov_b32 v42, 0
v_mov_b32 v43, 0
v_mov_b32 v44, 0
v_mov_b32 v45, 0
v_mov_b32 v46, 0
v_mov_b32 v47, 0
v_mov_b32 v48, 0
v_mov_b32 v49, 0
v_mov_b32 v50, 0
v_mov_b32 v51, 0
v_mov_b32 v52, 0
v_mov_b32 v53, 0
v_mov_b32 v54, 0
v_mov_b32 v55, 0
s_cmp_ge_u32 s2, 256
s_cbranch_scc1 ka_ffn
v_lshlrev_b32 v12, 3, v4
ds_read_b64 v[16:17], v12 offset:0
s_waitcnt vmcnt(7) lgkmcnt(0)
v_lshlrev_b32 v18, 16, v64
v_and_b32 v19, 0xffff0000, v64
v_fmac_f32 v40, v18, v16
v_fmac_f32 v48, v18, v17
v_fmac_f32 v41, v19, v16
v_fmac_f32 v49, v19, v17
v_lshlrev_b32 v18, 16, v65
v_and_b32 v19, 0xffff0000, v65
v_fmac_f32 v42, v18, v16
v_fmac_f32 v50, v18, v17
v_fmac_f32 v43, v19, v16
v_fmac_f32 v51, v19, v17
v_lshlrev_b32 v18, 16, v66
v_and_b32 v19, 0xffff0000, v66
v_fmac_f32 v44, v18, v16
v_fmac_f32 v52, v18, v17
v_fmac_f32 v45, v19, v16
v_fmac_f32 v53, v19, v17
v_lshlrev_b32 v18, 16, v67
v_and_b32 v19, 0xffff0000, v67
v_fmac_f32 v46, v18, v16
v_fmac_f32 v54, v18, v17
v_fmac_f32 v47, v19, v16
v_fmac_f32 v55, v19, v17
global_load_dwordx4 v[64:67], v5, s[20:21]
v_add_u32 v5, 131072, v5
ds_read_b64 v[16:17], v12 offset:128
s_waitcnt vmcnt(7) lgkmcnt(0)
v_lshlrev_b32 v18, 16, v68
v_and_b32 v19, 0xffff0000, v68
v_fmac_f32 v40, v18, v16
v_fmac_f32 v48, v18, v17
v_fmac_f32 v41, v19, v16
v_fmac_f32 v49, v19, v17
v_lshlrev_b32 v18, 16, v69
v_and_b32 v19, 0xffff0000, v69
v_fmac_f32 v42, v18, v16
v_fmac_f32 v50, v18, v17
v_fmac_f32 v43, v19, v16
v_fmac_f32 v51, v19, v17
v_lshlrev_b32 v18, 16, v70
v_and_b32 v19, 0xffff0000, v70
v_fmac_f32 v44, v18, v16
v_fmac_f32 v52, v18, v17
v_fmac_f32 v45, v19, v16
v_fmac_f32 v53, v19, v17
v_lshlrev_b32 v18, 16, v71
v_and_b32 v19, 0xffff0000, v71
v_fmac_f32 v46, v18, v16
v_fmac_f32 v54, v18, v17
v_fmac_f32 v47, v19, v16
v_fmac_f32 v55, v19, v17
global_load_dwordx4 v[68:71], v5, s[20:21]
v_add_u32 v5, 131072, v5
ds_read_b64 v[16:17], v12 offset:256
s_waitcnt vmcnt(7) lgkmcnt(0)
v_lshlrev_b32 v18, 16, v72
v_and_b32 v19, 0xffff0000, v72
v_fmac_f32 v40, v18, v16
v_fmac_f32 v48, v18, v17
v_fmac_f32 v41, v19, v16
v_fmac_f32 v49, v19, v17
v_lshlrev_b32 v18, 16, v73
v_and_b32 v19, 0xffff0000, v73
v_fmac_f32 v42, v18, v16
v_fmac_f32 v50, v18, v17
v_fmac_f32 v43, v19, v16
v_fmac_f32 v51, v19, v17
v_lshlrev_b32 v18, 16, v74
v_and_b32 v19, 0xffff0000, v74
v_fmac_f32 v44, v18, v16
v_fmac_f32 v52, v18, v17
v_fmac_f32 v45, v19, v16
v_fmac_f32 v53, v19, v17
v_lshlrev_b32 v18, 16, v75
v_and_b32 v19, 0xffff0000, v75
v_fmac_f32 v46, v18, v16
v_fmac_f32 v54, v18, v17
v_fmac_f32 v47, v19, v16
v_fmac_f32 v55, v19, v17
global_load_dwordx4 v[72:75], v5, s[20:21]
v_add_u32 v5, 131072, v5
ds_read_b64 v[16:17], v12 offset:384
s_waitcnt vmcnt(7) lgkmcnt(0)
v_lshlrev_b32 v18, 16, v76
v_and_b32 v19, 0xffff0000, v76
v_fmac_f32 v40, v18, v16
v_fmac_f32 v48, v18, v17
v_fmac_f32 v41, v19, v16
v_fmac_f32 v49, v19, v17
v_lshlrev_b32 v18, 16, v77
v_and_b32 v19, 0xffff0000, v77
v_fmac_f32 v42, v18, v16
v_fmac_f32 v50, v18, v17
v_fmac_f32 v43, v19, v16
v_fmac_f32 v51, v19, v17
v_lshlrev_b32 v18, 16, v78
v_and_b32 v19, 0xffff0000, v78
v_fmac_f32 v44, v18, v16
v_fmac_f32 v52, v18, v17
v_fmac_f32 v45, v19, v16
v_fmac_f32 v53, v19, v17
v_lshlrev_b32 v18, 16, v79
v_and_b32 v19, 0xffff0000, v79
v_fmac_f32 v46, v18, v16
v_fmac_f32 v54, v18, v17
v_fmac_f32 v47, v19, v16
v_fmac_f32 v55, v19, v17
global_load_dwordx4 v[76:79], v5, s[20:21]
v_add_u32 v5, 131072, v5
ds_read_b64 v[16:17], v12 offset:512
s_waitcnt vmcnt(7) lgkmcnt(0)
v_lshlrev_b32 v18, 16, v80
v_and_b32 v19, 0xffff0000, v80
v_fmac_f32 v40, v18, v16
v_fmac_f32 v48, v18, v17
v_fmac_f32 v41, v19, v16
v_fmac_f32 v49, v19, v17
v_lshlrev_b32 v18, 16, v81
v_and_b32 v19, 0xffff0000, v81
v_fmac_f32 v42, v18, v16
v_fmac_f32 v50, v18, v17
v_fmac_f32 v43, v19, v16
v_fmac_f32 v51, v19, v17
v_lshlrev_b32 v18, 16, v82
v_and_b32 v19, 0xffff0000, v82
v_fmac_f32 v44, v18, v16
v_fmac_f32 v52, v18, v17
v_fmac_f32 v45, v19, v16
v_fmac_f32 v53, v19, v17
v_lshlrev_b32 v18, 16, v83
v_and_b32 v19, 0xffff0000, v83
v_fmac_f32 v46, v18, v16
v_fmac_f32 v54, v18, v17
v_fmac_f32 v47, v19, v16
v_fmac_f32 v55, v19, v17
global_load_dwordx4 v[80:83], v5, s[20:21]
v_add_u32 v5, 131072, v5
ds_read_b64 v[16:17], v12 offset:640
s_waitcnt vmcnt(7) lgkmcnt(0)
v_lshlrev_b32 v18, 16, v84
v_and_b32 v19, 0xffff0000, v84
v_fmac_f32 v40, v18, v16
v_fmac_f32 v48, v18, v17
v_fmac_f32 v41, v19, v16
v_fmac_f32 v49, v19, v17
v_lshlrev_b32 v18, 16, v85
v_and_b32 v19, 0xffff0000, v85
v_fmac_f32 v42, v18, v16
v_fmac_f32 v50, v18, v17
v_fmac_f32 v43, v19, v16
v_fmac_f32 v51, v19, v17
v_lshlrev_b32 v18, 16, v86
v_and_b32 v19, 0xffff0000, v86
v_fmac_f32 v44, v18, v16
v_fmac_f32 v52, v18, v17
v_fmac_f32 v45, v19, v16
v_fmac_f32 v53, v19, v17
v_lshlrev_b32 v18, 16, v87
v_and_b32 v19, 0xffff0000, v87
v_fmac_f32 v46, v18, v16
v_fmac_f32 v54, v18, v17
v_fmac_f32 v47, v19, v16
v_fmac_f32 v55, v19, v17
global_load_dwordx4 v[84:87], v5, s[20:21]
v_add_u32 v5, 131072, v5
ds_read_b64 v[16:17], v12 offset:768
s_waitcnt vmcnt(7) lgkmcnt(0)
v_lshlrev_b32 v18, 16, v88
v_and_b32 v19, 0xffff0000, v88
v_fmac_f32 v40, v18, v16
v_fmac_f32 v48, v18, v17
v_fmac_f32 v41, v19, v16
v_fmac_f32 v49, v19, v17
v_lshlrev_b32 v18, 16, v89
v_and_b32 v19, 0xffff0000, v89
v_fmac_f32 v42, v18, v16
v_fmac_f32 v50, v18, v17
v_fmac_f32 v43, v19, v16
v_fmac_f32 v51, v19, v17
v_lshlrev_b32 v18, 16, v90
v_and_b32 v19, 0xffff0000, v90
v_fmac_f32 v44, v18, v16
v_fmac_f32 v52, v18, v17
v_fmac_f32 v45, v19, v16
v_fmac_f32 v53, v19, v17
v_lshlrev_b32 v18, 16, v91
v_and_b32 v19, 0xffff0000, v91
v_fmac_f32 v46, v18, v16
v_fmac_f32 v54, v18, v17
v_fmac_f32 v47, v19, v16
v_fmac_f32 v55, v19, v17
global_load_dwordx4 v[88:91], v5, s[20:21]
v_add_u32 v5, 131072, v5
ds_read_b64 v[16:17], v12 offset:896
s_waitcnt vmcnt(7) lgkmcnt(0)
v_lshlrev_b32 v18, 16, v92
v_and_b32 v19, 0xffff0000, v92
v_fmac_f32 v40, v18, v16
v_fmac_f32 v48, v18, v17
v_fmac_f32 v41, v19, v16
v_fmac_f32 v49, v19, v17
v_lshlrev_b32 v18, 16, v93
v_and_b32 v19, 0xffff0000, v93
v_fmac_f32 v42, v18, v16
v_fmac_f32 v50, v18, v17
v_fmac_f32 v43, v19, v16
v_fmac_f32 v51, v19, v17
v_lshlrev_b32 v18, 16, v94
v_and_b32 v19, 0xffff0000, v94
v_fmac_f32 v44, v18, v16
v_fmac_f32 v52, v18, v17
v_fmac_f32 v45, v19, v16
v_fmac_f32 v53, v19, v17
v_lshlrev_b32 v18, 16, v95
v_and_b32 v19, 0xffff0000, v95
v_fmac_f32 v46, v18, v16
v_fmac_f32 v54, v18, v17
v_fmac_f32 v47, v19, v16
v_fmac_f32 v55, v19, v17
global_load_dwordx4 v[92:95], v5, s[20:21]
v_add_u32 v5, 131072, v5
ds_read_b64 v[16:17], v12 offset:1024
s_waitcnt vmcnt(7) lgkmcnt(0)
v_lshlrev_b32 v18, 16, v64
v_and_b32 v19, 0xffff0000, v64
v_fmac_f32 v40, v18, v16
v_fmac_f32 v48, v18, v17
v_fmac_f32 v41, v19, v16
v_fmac_f32 v49, v19, v17
v_lshlrev_b32 v18, 16, v65
v_and_b32 v19, 0xffff0000, v65
v_fmac_f32 v42, v18, v16
v_fmac_f32 v50, v18, v17
v_fmac_f32 v43, v19, v16
v_fmac_f32 v51, v19, v17
v_lshlrev_b32 v18, 16, v66
v_and_b32 v19, 0xffff0000, v66
v_fmac_f32 v44, v18, v16
v_fmac_f32 v52, v18, v17
v_fmac_f32 v45, v19, v16
v_fmac_f32 v53, v19, v17
v_lshlrev_b32 v18, 16, v67
v_and_b32 v19, 0xffff0000, v67
v_fmac_f32 v46, v18, v16
v_fmac_f32 v54, v18, v17
v_fmac_f32 v47, v19, v16
v_fmac_f32 v55, v19, v17
global_load_dwordx4 v[64:67], v5, s[20:21]
v_add_u32 v5, 131072, v5
ds_read_b64 v[16:17], v12 offset:1152
s_waitcnt vmcnt(7) lgkmcnt(0)
v_lshlrev_b32 v18, 16, v68
v_and_b32 v19, 0xffff0000, v68
v_fmac_f32 v40, v18, v16
v_fmac_f32 v48, v18, v17
v_fmac_f32 v41, v19, v16
v_fmac_f32 v49, v19, v17
v_lshlrev_b32 v18, 16, v69
v_and_b32 v19, 0xffff0000, v69
v_fmac_f32 v42, v18, v16
v_fmac_f32 v50, v18, v17
v_fmac_f32 v43, v19, v16
v_fmac_f32 v51, v19, v17
v_lshlrev_b32 v18, 16, v70
v_and_b32 v19, 0xffff0000, v70
v_fmac_f32 v44, v18, v16
v_fmac_f32 v52, v18, v17
v_fmac_f32 v45, v19, v16
v_fmac_f32 v53, v19, v17
v_lshlrev_b32 v18, 16, v71
v_and_b32 v19, 0xffff0000, v71
v_fmac_f32 v46, v18, v16
v_fmac_f32 v54, v18, v17
v_fmac_f32 v47, v19, v16
v_fmac_f32 v55, v19, v17
global_load_dwordx4 v[68:71], v5, s[20:21]
v_add_u32 v5, 131072, v5
ds_read_b64 v[16:17], v12 offset:1280
s_waitcnt vmcnt(7) lgkmcnt(0)
v_lshlrev_b32 v18, 16, v72
v_and_b32 v19, 0xffff0000, v72
v_fmac_f32 v40, v18, v16
v_fmac_f32 v48, v18, v17
v_fmac_f32 v41, v19, v16
v_fmac_f32 v49, v19, v17
v_lshlrev_b32 v18, 16, v73
v_and_b32 v19, 0xffff0000, v73
v_fmac_f32 v42, v18, v16
v_fmac_f32 v50, v18, v17
v_fmac_f32 v43, v19, v16
v_fmac_f32 v51, v19, v17
v_lshlrev_b32 v18, 16, v74
v_and_b32 v19, 0xffff0000, v74
v_fmac_f32 v44, v18, v16
v_fmac_f32 v52, v18, v17
v_fmac_f32 v45, v19, v16
v_fmac_f32 v53, v19, v17
v_lshlrev_b32 v18, 16, v75
v_and_b32 v19, 0xffff0000, v75
v_fmac_f32 v46, v18, v16
v_fmac_f32 v54, v18, v17
v_fmac_f32 v47, v19, v16
v_fmac_f32 v55, v19, v17
global_load_dwordx4 v[72:75], v5, s[20:21]
v_add_u32 v5, 131072, v5
ds_read_b64 v[16:17], v12 offset:1408
s_waitcnt vmcnt(7) lgkmcnt(0)
v_lshlrev_b32 v18, 16, v76
v_and_b32 v19, 0xffff0000, v76
v_fmac_f32 v40, v18, v16
v_fmac_f32 v48, v18, v17
v_fmac_f32 v41, v19, v16
v_fmac_f32 v49, v19, v17
v_lshlrev_b32 v18, 16, v77
v_and_b32 v19, 0xffff0000, v77
v_fmac_f32 v42, v18, v16
v_fmac_f32 v50, v18, v17
v_fmac_f32 v43, v19, v16
v_fmac_f32 v51, v19, v17
v_lshlrev_b32 v18, 16, v78
v_and_b32 v19, 0xffff0000, v78
v_fmac_f32 v44, v18, v16
v_fmac_f32 v52, v18, v17
v_fmac_f32 v45, v19, v16
v_fmac_f32 v53, v19, v17
v_lshlrev_b32 v18, 16, v79
v_and_b32 v19, 0xffff0000, v79
v_fmac_f32 v46, v18, v16
v_fmac_f32 v54, v18, v17
v_fmac_f32 v47, v19, v16
v_fmac_f32 v55, v19, v17
global_load_dwordx4 v[76:79], v5, s[20:21]
v_add_u32 v5, 131072, v5
ds_read_b64 v[16:17], v12 offset:1536
s_waitcnt vmcnt(7) lgkmcnt(0)
v_lshlrev_b32 v18, 16, v80
v_and_b32 v19, 0xffff0000, v80
v_fmac_f32 v40, v18, v16
v_fmac_f32 v48, v18, v17
v_fmac_f32 v41, v19, v16
v_fmac_f32 v49, v19, v17
v_lshlrev_b32 v18, 16, v81
v_and_b32 v19, 0xffff0000, v81
v_fmac_f32 v42, v18, v16
v_fmac_f32 v50, v18, v17
v_fmac_f32 v43, v19, v16
v_fmac_f32 v51, v19, v17
v_lshlrev_b32 v18, 16, v82
v_and_b32 v19, 0xffff0000, v82
v_fmac_f32 v44, v18, v16
v_fmac_f32 v52, v18, v17
v_fmac_f32 v45, v19, v16
v_fmac_f32 v53, v19, v17
v_lshlrev_b32 v18, 16, v83
v_and_b32 v19, 0xffff0000, v83
v_fmac_f32 v46, v18, v16
v_fmac_f32 v54, v18, v17
v_fmac_f32 v47, v19, v16
v_fmac_f32 v55, v19, v17
global_load_dwordx4 v[80:83], v5, s[20:21]
v_add_u32 v5, 131072, v5
ds_read_b64 v[16:17], v12 offset:1664
s_waitcnt vmcnt(7) lgkmcnt(0)
v_lshlrev_b32 v18, 16, v84
v_and_b32 v19, 0xffff0000, v84
v_fmac_f32 v40, v18, v16
v_fmac_f32 v48, v18, v17
v_fmac_f32 v41, v19, v16
v_fmac_f32 v49, v19, v17
v_lshlrev_b32 v18, 16, v85
v_and_b32 v19, 0xffff0000, v85
v_fmac_f32 v42, v18, v16
v_fmac_f32 v50, v18, v17
v_fmac_f32 v43, v19, v16
v_fmac_f32 v51, v19, v17
v_lshlrev_b32 v18, 16, v86
v_and_b32 v19, 0xffff0000, v86
v_fmac_f32 v44, v18, v16
v_fmac_f32 v52, v18, v17
v_fmac_f32 v45, v19, v16
v_fmac_f32 v53, v19, v17
v_lshlrev_b32 v18, 16, v87
v_and_b32 v19, 0xffff0000, v87
v_fmac_f32 v46, v18, v16
v_fmac_f32 v54, v18, v17
v_fmac_f32 v47, v19, v16
v_fmac_f32 v55, v19, v17
global_load_dwordx4 v[84:87], v5, s[20:21]
v_add_u32 v5, 131072, v5
ds_read_b64 v[16:17], v12 offset:1792
s_waitcnt vmcnt(7) lgkmcnt(0)
v_lshlrev_b32 v18, 16, v88
v_and_b32 v19, 0xffff0000, v88
v_fmac_f32 v40, v18, v16
v_fmac_f32 v48, v18, v17
v_fmac_f32 v41, v19, v16
v_fmac_f32 v49, v19, v17
v_lshlrev_b32 v18, 16, v89
v_and_b32 v19, 0xffff0000, v89
v_fmac_f32 v42, v18, v16
v_fmac_f32 v50, v18, v17
v_fmac_f32 v43, v19, v16
v_fmac_f32 v51, v19, v17
v_lshlrev_b32 v18, 16, v90
v_and_b32 v19, 0xffff0000, v90
v_fmac_f32 v44, v18, v16
v_fmac_f32 v52, v18, v17
v_fmac_f32 v45, v19, v16
v_fmac_f32 v53, v19, v17
v_lshlrev_b32 v18, 16, v91
v_and_b32 v19, 0xffff0000, v91
v_fmac_f32 v46, v18, v16
v_fmac_f32 v54, v18, v17
v_fmac_f32 v47, v19, v16
v_fmac_f32 v55, v19, v17
global_load_dwordx4 v[88:91], v5, s[20:21]
v_add_u32 v5, 131072, v5
ds_read_b64 v[16:17], v12 offset:1920
s_waitcnt vmcnt(7) lgkmcnt(0)
v_lshlrev_b32 v18, 16, v92
v_and_b32 v19, 0xffff0000, v92
v_fmac_f32 v40, v18, v16
v_fmac_f32 v48, v18, v17
v_fmac_f32 v41, v19, v16
v_fmac_f32 v49, v19, v17
v_lshlrev_b32 v18, 16, v93
v_and_b32 v19, 0xffff0000, v93
v_fmac_f32 v42, v18, v16
v_fmac_f32 v50, v18, v17
v_fmac_f32 v43, v19, v16
v_fmac_f32 v51, v19, v17
v_lshlrev_b32 v18, 16, v94
v_and_b32 v19, 0xffff0000, v94
v_fmac_f32 v44, v18, v16
v_fmac_f32 v52, v18, v17
v_fmac_f32 v45, v19, v16
v_fmac_f32 v53, v19, v17
v_lshlrev_b32 v18, 16, v95
v_and_b32 v19, 0xffff0000, v95
v_fmac_f32 v46, v18, v16
v_fmac_f32 v54, v18, v17
v_fmac_f32 v47, v19, v16
v_fmac_f32 v55, v19, v17
global_load_dwordx4 v[92:95], v5, s[20:21]
v_add_u32 v5, 131072, v5
ds_read_b64 v[16:17], v12 offset:2048
s_waitcnt vmcnt(7) lgkmcnt(0)
v_lshlrev_b32 v18, 16, v64
v_and_b32 v19, 0xffff0000, v64
v_fmac_f32 v40, v18, v16
v_fmac_f32 v48, v18, v17
v_fmac_f32 v41, v19, v16
v_fmac_f32 v49, v19, v17
v_lshlrev_b32 v18, 16, v65
v_and_b32 v19, 0xffff0000, v65
v_fmac_f32 v42, v18, v16
v_fmac_f32 v50, v18, v17
v_fmac_f32 v43, v19, v16
v_fmac_f32 v51, v19, v17
v_lshlrev_b32 v18, 16, v66
v_and_b32 v19, 0xffff0000, v66
v_fmac_f32 v44, v18, v16
v_fmac_f32 v52, v18, v17
v_fmac_f32 v45, v19, v16
v_fmac_f32 v53, v19, v17
v_lshlrev_b32 v18, 16, v67
v_and_b32 v19, 0xffff0000, v67
v_fmac_f32 v46, v18, v16
v_fmac_f32 v54, v18, v17
v_fmac_f32 v47, v19, v16
v_fmac_f32 v55, v19, v17
global_load_dwordx4 v[64:67], v5, s[20:21]
v_add_u32 v5, 131072, v5
ds_read_b64 v[16:17], v12 offset:2176
s_waitcnt vmcnt(7) lgkmcnt(0)
v_lshlrev_b32 v18, 16, v68
v_and_b32 v19, 0xffff0000, v68
v_fmac_f32 v40, v18, v16
v_fmac_f32 v48, v18, v17
v_fmac_f32 v41, v19, v16
v_fmac_f32 v49, v19, v17
v_lshlrev_b32 v18, 16, v69
v_and_b32 v19, 0xffff0000, v69
v_fmac_f32 v42, v18, v16
v_fmac_f32 v50, v18, v17
v_fmac_f32 v43, v19, v16
v_fmac_f32 v51, v19, v17
v_lshlrev_b32 v18, 16, v70
v_and_b32 v19, 0xffff0000, v70
v_fmac_f32 v44, v18, v16
v_fmac_f32 v52, v18, v17
v_fmac_f32 v45, v19, v16
v_fmac_f32 v53, v19, v17
v_lshlrev_b32 v18, 16, v71
v_and_b32 v19, 0xffff0000, v71
v_fmac_f32 v46, v18, v16
v_fmac_f32 v54, v18, v17
v_fmac_f32 v47, v19, v16
v_fmac_f32 v55, v19, v17
global_load_dwordx4 v[68:71], v5, s[20:21]
v_add_u32 v5, 131072, v5
ds_read_b64 v[16:17], v12 offset:2304
s_waitcnt vmcnt(7) lgkmcnt(0)
v_lshlrev_b32 v18, 16, v72
v_and_b32 v19, 0xffff0000, v72
v_fmac_f32 v40, v18, v16
v_fmac_f32 v48, v18, v17
v_fmac_f32 v41, v19, v16
v_fmac_f32 v49, v19, v17
v_lshlrev_b32 v18, 16, v73
v_and_b32 v19, 0xffff0000, v73
v_fmac_f32 v42, v18, v16
v_fmac_f32 v50, v18, v17
v_fmac_f32 v43, v19, v16
v_fmac_f32 v51, v19, v17
v_lshlrev_b32 v18, 16, v74
v_and_b32 v19, 0xffff0000, v74
v_fmac_f32 v44, v18, v16
v_fmac_f32 v52, v18, v17
v_fmac_f32 v45, v19, v16
v_fmac_f32 v53, v19, v17
v_lshlrev_b32 v18, 16, v75
v_and_b32 v19, 0xffff0000, v75
v_fmac_f32 v46, v18, v16
v_fmac_f32 v54, v18, v17
v_fmac_f32 v47, v19, v16
v_fmac_f32 v55, v19, v17
global_load_dwordx4 v[72:75], v5, s[20:21]
v_add_u32 v5, 131072, v5
ds_read_b64 v[16:17], v12 offset:2432
s_waitcnt vmcnt(7) lgkmcnt(0)
v_lshlrev_b32 v18, 16, v76
v_and_b32 v19, 0xffff0000, v76
v_fmac_f32 v40, v18, v16
v_fmac_f32 v48, v18, v17
v_fmac_f32 v41, v19, v16
v_fmac_f32 v49, v19, v17
v_lshlrev_b32 v18, 16, v77
v_and_b32 v19, 0xffff0000, v77
v_fmac_f32 v42, v18, v16
v_fmac_f32 v50, v18, v17
v_fmac_f32 v43, v19, v16
v_fmac_f32 v51, v19, v17
v_lshlrev_b32 v18, 16, v78
v_and_b32 v19, 0xffff0000, v78
v_fmac_f32 v44, v18, v16
v_fmac_f32 v52, v18, v17
v_fmac_f32 v45, v19, v16
v_fmac_f32 v53, v19, v17
v_lshlrev_b32 v18, 16, v79
v_and_b32 v19, 0xffff0000, v79
v_fmac_f32 v46, v18, v16
v_fmac_f32 v54, v18, v17
v_fmac_f32 v47, v19, v16
v_fmac_f32 v55, v19, v17
global_load_dwordx4 v[76:79], v5, s[20:21]
v_add_u32 v5, 131072, v5
ds_read_b64 v[16:17], v12 offset:2560
s_waitcnt vmcnt(7) lgkmcnt(0)
v_lshlrev_b32 v18, 16, v80
v_and_b32 v19, 0xffff0000, v80
v_fmac_f32 v40, v18, v16
v_fmac_f32 v48, v18, v17
v_fmac_f32 v41, v19, v16
v_fmac_f32 v49, v19, v17
v_lshlrev_b32 v18, 16, v81
v_and_b32 v19, 0xffff0000, v81
v_fmac_f32 v42, v18, v16
v_fmac_f32 v50, v18, v17
v_fmac_f32 v43, v19, v16
v_fmac_f32 v51, v19, v17
v_lshlrev_b32 v18, 16, v82
v_and_b32 v19, 0xffff0000, v82
v_fmac_f32 v44, v18, v16
v_fmac_f32 v52, v18, v17
v_fmac_f32 v45, v19, v16
v_fmac_f32 v53, v19, v17
v_lshlrev_b32 v18, 16, v83
v_and_b32 v19, 0xffff0000, v83
v_fmac_f32 v46, v18, v16
v_fmac_f32 v54, v18, v17
v_fmac_f32 v47, v19, v16
v_fmac_f32 v55, v19, v17
ds_read_b64 v[16:17], v12 offset:2688
s_waitcnt vmcnt(6) lgkmcnt(0)
v_lshlrev_b32 v18, 16, v84
v_and_b32 v19, 0xffff0000, v84
v_fmac_f32 v40, v18, v16
v_fmac_f32 v48, v18, v17
v_fmac_f32 v41, v19, v16
v_fmac_f32 v49, v19, v17
v_lshlrev_b32 v18, 16, v85
v_and_b32 v19, 0xffff0000, v85
v_fmac_f32 v42, v18, v16
v_fmac_f32 v50, v18, v17
v_fmac_f32 v43, v19, v16
v_fmac_f32 v51, v19, v17
v_lshlrev_b32 v18, 16, v86
v_and_b32 v19, 0xffff0000, v86
v_fmac_f32 v44, v18, v16
v_fmac_f32 v52, v18, v17
v_fmac_f32 v45, v19, v16
v_fmac_f32 v53, v19, v17
v_lshlrev_b32 v18, 16, v87
v_and_b32 v19, 0xffff0000, v87
v_fmac_f32 v46, v18, v16
v_fmac_f32 v54, v18, v17
v_fmac_f32 v47, v19, v16
v_fmac_f32 v55, v19, v17
ds_read_b64 v[16:17], v12 offset:2816
s_waitcnt vmcnt(5) lgkmcnt(0)
v_lshlrev_b32 v18, 16, v88
v_and_b32 v19, 0xffff0000, v88
v_fmac_f32 v40, v18, v16
v_fmac_f32 v48, v18, v17
v_fmac_f32 v41, v19, v16
v_fmac_f32 v49, v19, v17
v_lshlrev_b32 v18, 16, v89
v_and_b32 v19, 0xffff0000, v89
v_fmac_f32 v42, v18, v16
v_fmac_f32 v50, v18, v17
v_fmac_f32 v43, v19, v16
v_fmac_f32 v51, v19, v17
v_lshlrev_b32 v18, 16, v90
v_and_b32 v19, 0xffff0000, v90
v_fmac_f32 v44, v18, v16
v_fmac_f32 v52, v18, v17
v_fmac_f32 v45, v19, v16
v_fmac_f32 v53, v19, v17
v_lshlrev_b32 v18, 16, v91
v_and_b32 v19, 0xffff0000, v91
v_fmac_f32 v46, v18, v16
v_fmac_f32 v54, v18, v17
v_fmac_f32 v47, v19, v16
v_fmac_f32 v55, v19, v17
ds_read_b64 v[16:17], v12 offset:2944
s_waitcnt vmcnt(4) lgkmcnt(0)
v_lshlrev_b32 v18, 16, v92
v_and_b32 v19, 0xffff0000, v92
v_fmac_f32 v40, v18, v16
v_fmac_f32 v48, v18, v17
v_fmac_f32 v41, v19, v16
v_fmac_f32 v49, v19, v17
v_lshlrev_b32 v18, 16, v93
v_and_b32 v19, 0xffff0000, v93
v_fmac_f32 v42, v18, v16
v_fmac_f32 v50, v18, v17
v_fmac_f32 v43, v19, v16
v_fmac_f32 v51, v19, v17
v_lshlrev_b32 v18, 16, v94
v_and_b32 v19, 0xffff0000, v94
v_fmac_f32 v44, v18, v16
v_fmac_f32 v52, v18, v17
v_fmac_f32 v45, v19, v16
v_fmac_f32 v53, v19, v17
v_lshlrev_b32 v18, 16, v95
v_and_b32 v19, 0xffff0000, v95
v_fmac_f32 v46, v18, v16
v_fmac_f32 v54, v18, v17
v_fmac_f32 v47, v19, v16
v_fmac_f32 v55, v19, v17
ds_read_b64 v[16:17], v12 offset:3072
s_waitcnt vmcnt(3) lgkmcnt(0)
v_lshlrev_b32 v18, 16, v64
v_and_b32 v19, 0xffff0000, v64
v_fmac_f32 v40, v18, v16
v_fmac_f32 v48, v18, v17
v_fmac_f32 v41, v19, v16
v_fmac_f32 v49, v19, v17
v_lshlrev_b32 v18, 16, v65
v_and_b32 v19, 0xffff0000, v65
v_fmac_f32 v42, v18, v16
v_fmac_f32 v50, v18, v17
v_fmac_f32 v43, v19, v16
v_fmac_f32 v51, v19, v17
v_lshlrev_b32 v18, 16, v66
v_and_b32 v19, 0xffff0000, v66
v_fmac_f32 v44, v18, v16
v_fmac_f32 v52, v18, v17
v_fmac_f32 v45, v19, v16
v_fmac_f32 v53, v19, v17
v_lshlrev_b32 v18, 16, v67
v_and_b32 v19, 0xffff0000, v67
v_fmac_f32 v46, v18, v16
v_fmac_f32 v54, v18, v17
v_fmac_f32 v47, v19, v16
v_fmac_f32 v55, v19, v17
ds_read_b64 v[16:17], v12 offset:3200
s_waitcnt vmcnt(2) lgkmcnt(0)
v_lshlrev_b32 v18, 16, v68
v_and_b32 v19, 0xffff0000, v68
v_fmac_f32 v40, v18, v16
v_fmac_f32 v48, v18, v17
v_fmac_f32 v41, v19, v16
v_fmac_f32 v49, v19, v17
v_lshlrev_b32 v18, 16, v69
v_and_b32 v19, 0xffff0000, v69
v_fmac_f32 v42, v18, v16
v_fmac_f32 v50, v18, v17
v_fmac_f32 v43, v19, v16
v_fmac_f32 v51, v19, v17
v_lshlrev_b32 v18, 16, v70
v_and_b32 v19, 0xffff0000, v70
v_fmac_f32 v44, v18, v16
v_fmac_f32 v52, v18, v17
v_fmac_f32 v45, v19, v16
v_fmac_f32 v53, v19, v17
v_lshlrev_b32 v18, 16, v71
v_and_b32 v19, 0xffff0000, v71
v_fmac_f32 v46, v18, v16
v_fmac_f32 v54, v18, v17
v_fmac_f32 v47, v19, v16
v_fmac_f32 v55, v19, v17
ds_read_b64 v[16:17], v12 offset:3328
s_waitcnt vmcnt(1) lgkmcnt(0)
v_lshlrev_b32 v18, 16, v72
v_and_b32 v19, 0xffff0000, v72
v_fmac_f32 v40, v18, v16
v_fmac_f32 v48, v18, v17
v_fmac_f32 v41, v19, v16
v_fmac_f32 v49, v19, v17
v_lshlrev_b32 v18, 16, v73
v_and_b32 v19, 0xffff0000, v73
v_fmac_f32 v42, v18, v16
v_fmac_f32 v50, v18, v17
v_fmac_f32 v43, v19, v16
v_fmac_f32 v51, v19, v17
v_lshlrev_b32 v18, 16, v74
v_and_b32 v19, 0xffff0000, v74
v_fmac_f32 v44, v18, v16
v_fmac_f32 v52, v18, v17
v_fmac_f32 v45, v19, v16
v_fmac_f32 v53, v19, v17
v_lshlrev_b32 v18, 16, v75
v_and_b32 v19, 0xffff0000, v75
v_fmac_f32 v46, v18, v16
v_fmac_f32 v54, v18, v17
v_fmac_f32 v47, v19, v16
v_fmac_f32 v55, v19, v17
ds_read_b64 v[16:17], v12 offset:3456
s_waitcnt vmcnt(0) lgkmcnt(0)
v_lshlrev_b32 v18, 16, v76
v_and_b32 v19, 0xffff0000, v76
v_fmac_f32 v40, v18, v16
v_fmac_f32 v48, v18, v17
v_fmac_f32 v41, v19, v16
v_fmac_f32 v49, v19, v17
v_lshlrev_b32 v18, 16, v77
v_and_b32 v19, 0xffff0000, v77
v_fmac_f32 v42, v18, v16
v_fmac_f32 v50, v18, v17
v_fmac_f32 v43, v19, v16
v_fmac_f32 v51, v19, v17
v_lshlrev_b32 v18, 16, v78
v_and_b32 v19, 0xffff0000, v78
v_fmac_f32 v44, v18, v16
v_fmac_f32 v52, v18, v17
v_fmac_f32 v45, v19, v16
v_fmac_f32 v53, v19, v17
v_lshlrev_b32 v18, 16, v79
v_and_b32 v19, 0xffff0000, v79
v_fmac_f32 v46, v18, v16
v_fmac_f32 v54, v18, v17
v_fmac_f32 v47, v19, v16
v_fmac_f32 v55, v19, v17
v_lshlrev_b32 v12, 11, v4
v_lshl_add_u32 v12, v3, 5, v12
v_add_u32 v12, 4096, v12
ds_write_b128 v12, v[40:43]
ds_write_b128 v12, v[44:47] offset:16
ds_write_b128 v12, v[48:51] offset:1024
ds_write_b128 v12, v[52:55] offset:1040
s_waitcnt lgkmcnt(0)
s_barrier
v_lshlrev_b32 v12, 2, v0
v_mov_b32 v13, 0
ds_read_b32 v64, v12 offset:4096
ds_read_b32 v65, v12 offset:6144
ds_read_b32 v66, v12 offset:8192
ds_read_b32 v67, v12 offset:10240
ds_read_b32 v68, v12 offset:12288
ds_read_b32 v69, v12 offset:14336
ds_read_b32 v70, v12 offset:16384
ds_read_b32 v71, v12 offset:18432
ds_read_b32 v72, v12 offset:20480
ds_read_b32 v73, v12 offset:22528
ds_read_b32 v74, v12 offset:24576
ds_read_b32 v75, v12 offset:26624
ds_read_b32 v76, v12 offset:28672
ds_read_b32 v77, v12 offset:30720
ds_read_b32 v78, v12 offset:32768
ds_read_b32 v79, v12 offset:34816
s_waitcnt lgkmcnt(0)
v_add_f32 v13, v13, v64
v_add_f32 v13, v13, v65
v_add_f32 v13, v13, v66
v_add_f32 v13, v13, v67
v_add_f32 v13, v13, v68
v_add_f32 v13, v13, v69
v_add_f32 v13, v13, v70
v_add_f32 v13, v13, v71
v_add_f32 v13, v13, v72
v_add_f32 v13, v13, v73
v_add_f32 v13, v13, v74
v_add_f32 v13, v13, v75
v_add_f32 v13, v13, v76
v_add_f32 v13, v13, v77
v_add_f32 v13, v13, v78
v_add_f32 v13, v13, v79
v_cvt_pk_bf16_f32 v13, v13, v13
v_lshlrev_b32 v12, 1, v0
ds_write_b16 v12, v13 offset:40960
s_waitcnt lgkmcnt(0)
s_barrier
s_cmp_ge_u32 s3, 4
s_cbranch_scc1 ka_kernel_end
v_and_b32 v12, 15, v1
v_lshlrev_b32 v12, 9, v12
v_lshl_add_u32 v12, v7, 4, v12
ds_read_b128 v[64:67], v12 offset:40960
ds_read_b128 v[68:71], v12 offset:41024
ds_read_b128 v[72:75], v12 offset:41088
ds_read_b128 v[76:79], v12 offset:41152
ds_read_b128 v[80:83], v12 offset:41216
ds_read_b128 v[84:87], v12 offset:41280
ds_read_b128 v[88:91], v12 offset:41344
ds_read_b128 v[92:95], v12 offset:41408
v_mov_b32 v40, 0
v_mov_b32 v41, 0
v_mov_b32 v42, 0
v_mov_b32 v43, 0
s_waitcnt vmcnt(0) lgkmcnt(0)
v_mfma_f32_16x16x32_bf16 v[40:43], v[96:99], v[64:67], v[40:43]
v_mfma_f32_16x16x32_bf16 v[40:43], v[100:103], v[68:71], v[40:43]
v_mfma_f32_16x16x32_bf16 v[40:43], v[104:107], v[72:75], v[40:43]
v_mfma_f32_16x16x32_bf16 v[40:43], v[108:111], v[76:79], v[40:43]
v_mfma_f32_16x16x32_bf16 v[40:43], v[112:115], v[80:83], v[40:43]
v_mfma_f32_16x16x32_bf16 v[40:43], v[116:119], v[84:87], v[40:43]
v_mfma_f32_16x16x32_bf16 v[40:43], v[120:123], v[88:91], v[40:43]
v_mfma_f32_16x16x32_bf16 v[40:43], v[124:127], v[92:95], v[40:43]
s_nop 15
v_cvt_pk_bf16_f32 v44, v40, v41
v_cvt_pk_bf16_f32 v45, v42, v43
v_and_b32 v12, 15, v1
v_lshlrev_b32 v13, 15, v12
v_lshl_add_u32 v13, v7, 3, v13
s_lshl_b32 s9, s4, 11
s_lshl_b32 s7, s7, 1
s_add_u32 s9, s9, s7
v_add_u32 v13, s9, v13
v_cmp_gt_u32 vcc, 2, v12
s_and_saveexec_b64 s[10:11], vcc
global_store_dwordx2 v13, v[44:45], s[40:41]
s_branch ka_kernel_end
ka_ffn:
v_lshlrev_b32 v12, 3, v4
ds_read_b64 v[16:17], v12 offset:0
s_waitcnt vmcnt(13) lgkmcnt(0)
v_lshlrev_b32 v18, 16, v64
v_and_b32 v19, 0xffff0000, v64
v_fmac_f32 v40, v18, v16
v_fmac_f32 v48, v18, v17
v_fmac_f32 v41, v19, v16
v_fmac_f32 v49, v19, v17
v_lshlrev_b32 v18, 16, v65
v_and_b32 v19, 0xffff0000, v65
v_fmac_f32 v42, v18, v16
v_fmac_f32 v50, v18, v17
v_fmac_f32 v43, v19, v16
v_fmac_f32 v51, v19, v17
v_lshlrev_b32 v18, 16, v66
v_and_b32 v19, 0xffff0000, v66
v_fmac_f32 v44, v18, v16
v_fmac_f32 v52, v18, v17
v_fmac_f32 v45, v19, v16
v_fmac_f32 v53, v19, v17
v_lshlrev_b32 v18, 16, v67
v_and_b32 v19, 0xffff0000, v67
v_fmac_f32 v46, v18, v16
v_fmac_f32 v54, v18, v17
v_fmac_f32 v47, v19, v16
v_fmac_f32 v55, v19, v17
ds_read_b64 v[16:17], v12 offset:256
s_waitcnt vmcnt(12) lgkmcnt(0)
v_lshlrev_b32 v18, 16, v68
v_and_b32 v19, 0xffff0000, v68
v_fmac_f32 v40, v18, v16
v_fmac_f32 v48, v18, v17
v_fmac_f32 v41, v19, v16
v_fmac_f32 v49, v19, v17
v_lshlrev_b32 v18, 16, v69
v_and_b32 v19, 0xffff0000, v69
v_fmac_f32 v42, v18, v16
v_fmac_f32 v50, v18, v17
v_fmac_f32 v43, v19, v16
v_fmac_f32 v51, v19, v17
v_lshlrev_b32 v18, 16, v70
v_and_b32 v19, 0xffff0000, v70
v_fmac_f32 v44, v18, v16
v_fmac_f32 v52, v18, v17
v_fmac_f32 v45, v19, v16
v_fmac_f32 v53, v19, v17
v_lshlrev_b32 v18, 16, v71
v_and_b32 v19, 0xffff0000, v71
v_fmac_f32 v46, v18, v16
v_fmac_f32 v54, v18, v17
v_fmac_f32 v47, v19, v16
v_fmac_f32 v55, v19, v17
ds_read_b64 v[16:17], v12 offset:512
s_waitcnt vmcnt(11) lgkmcnt(0)
v_lshlrev_b32 v18, 16, v72
v_and_b32 v19, 0xffff0000, v72
v_fmac_f32 v40, v18, v16
v_fmac_f32 v48, v18, v17
v_fmac_f32 v41, v19, v16
v_fmac_f32 v49, v19, v17
v_lshlrev_b32 v18, 16, v73
v_and_b32 v19, 0xffff0000, v73
v_fmac_f32 v42, v18, v16
v_fmac_f32 v50, v18, v17
v_fmac_f32 v43, v19, v16
v_fmac_f32 v51, v19, v17
v_lshlrev_b32 v18, 16, v74
v_and_b32 v19, 0xffff0000, v74
v_fmac_f32 v44, v18, v16
v_fmac_f32 v52, v18, v17
v_fmac_f32 v45, v19, v16
v_fmac_f32 v53, v19, v17
v_lshlrev_b32 v18, 16, v75
v_and_b32 v19, 0xffff0000, v75
v_fmac_f32 v46, v18, v16
v_fmac_f32 v54, v18, v17
v_fmac_f32 v47, v19, v16
v_fmac_f32 v55, v19, v17
ds_read_b64 v[16:17], v12 offset:768
s_waitcnt vmcnt(10) lgkmcnt(0)
v_lshlrev_b32 v18, 16, v76
v_and_b32 v19, 0xffff0000, v76
v_fmac_f32 v40, v18, v16
v_fmac_f32 v48, v18, v17
v_fmac_f32 v41, v19, v16
v_fmac_f32 v49, v19, v17
v_lshlrev_b32 v18, 16, v77
v_and_b32 v19, 0xffff0000, v77
v_fmac_f32 v42, v18, v16
v_fmac_f32 v50, v18, v17
v_fmac_f32 v43, v19, v16
v_fmac_f32 v51, v19, v17
v_lshlrev_b32 v18, 16, v78
v_and_b32 v19, 0xffff0000, v78
v_fmac_f32 v44, v18, v16
v_fmac_f32 v52, v18, v17
v_fmac_f32 v45, v19, v16
v_fmac_f32 v53, v19, v17
v_lshlrev_b32 v18, 16, v79
v_and_b32 v19, 0xffff0000, v79
v_fmac_f32 v46, v18, v16
v_fmac_f32 v54, v18, v17
v_fmac_f32 v47, v19, v16
v_fmac_f32 v55, v19, v17
ds_read_b64 v[16:17], v12 offset:1024
s_waitcnt vmcnt(9) lgkmcnt(0)
v_lshlrev_b32 v18, 16, v80
v_and_b32 v19, 0xffff0000, v80
v_fmac_f32 v40, v18, v16
v_fmac_f32 v48, v18, v17
v_fmac_f32 v41, v19, v16
v_fmac_f32 v49, v19, v17
v_lshlrev_b32 v18, 16, v81
v_and_b32 v19, 0xffff0000, v81
v_fmac_f32 v42, v18, v16
v_fmac_f32 v50, v18, v17
v_fmac_f32 v43, v19, v16
v_fmac_f32 v51, v19, v17
v_lshlrev_b32 v18, 16, v82
v_and_b32 v19, 0xffff0000, v82
v_fmac_f32 v44, v18, v16
v_fmac_f32 v52, v18, v17
v_fmac_f32 v45, v19, v16
v_fmac_f32 v53, v19, v17
v_lshlrev_b32 v18, 16, v83
v_and_b32 v19, 0xffff0000, v83
v_fmac_f32 v46, v18, v16
v_fmac_f32 v54, v18, v17
v_fmac_f32 v47, v19, v16
v_fmac_f32 v55, v19, v17
ds_read_b64 v[16:17], v12 offset:1280
s_waitcnt vmcnt(8) lgkmcnt(0)
v_lshlrev_b32 v18, 16, v84
v_and_b32 v19, 0xffff0000, v84
v_fmac_f32 v40, v18, v16
v_fmac_f32 v48, v18, v17
v_fmac_f32 v41, v19, v16
v_fmac_f32 v49, v19, v17
v_lshlrev_b32 v18, 16, v85
v_and_b32 v19, 0xffff0000, v85
v_fmac_f32 v42, v18, v16
v_fmac_f32 v50, v18, v17
v_fmac_f32 v43, v19, v16
v_fmac_f32 v51, v19, v17
v_lshlrev_b32 v18, 16, v86
v_and_b32 v19, 0xffff0000, v86
v_fmac_f32 v44, v18, v16
v_fmac_f32 v52, v18, v17
v_fmac_f32 v45, v19, v16
v_fmac_f32 v53, v19, v17
v_lshlrev_b32 v18, 16, v87
v_and_b32 v19, 0xffff0000, v87
v_fmac_f32 v46, v18, v16
v_fmac_f32 v54, v18, v17
v_fmac_f32 v47, v19, v16
v_fmac_f32 v55, v19, v17
ds_read_b64 v[16:17], v12 offset:1536
s_waitcnt vmcnt(7) lgkmcnt(0)
v_lshlrev_b32 v18, 16, v88
v_and_b32 v19, 0xffff0000, v88
v_fmac_f32 v40, v18, v16
v_fmac_f32 v48, v18, v17
v_fmac_f32 v41, v19, v16
v_fmac_f32 v49, v19, v17
v_lshlrev_b32 v18, 16, v89
v_and_b32 v19, 0xffff0000, v89
v_fmac_f32 v42, v18, v16
v_fmac_f32 v50, v18, v17
v_fmac_f32 v43, v19, v16
v_fmac_f32 v51, v19, v17
v_lshlrev_b32 v18, 16, v90
v_and_b32 v19, 0xffff0000, v90
v_fmac_f32 v44, v18, v16
v_fmac_f32 v52, v18, v17
v_fmac_f32 v45, v19, v16
v_fmac_f32 v53, v19, v17
v_lshlrev_b32 v18, 16, v91
v_and_b32 v19, 0xffff0000, v91
v_fmac_f32 v46, v18, v16
v_fmac_f32 v54, v18, v17
v_fmac_f32 v47, v19, v16
v_fmac_f32 v55, v19, v17
ds_read_b64 v[16:17], v12 offset:1792
s_waitcnt vmcnt(6) lgkmcnt(0)
v_lshlrev_b32 v18, 16, v92
v_and_b32 v19, 0xffff0000, v92
v_fmac_f32 v40, v18, v16
v_fmac_f32 v48, v18, v17
v_fmac_f32 v41, v19, v16
v_fmac_f32 v49, v19, v17
v_lshlrev_b32 v18, 16, v93
v_and_b32 v19, 0xffff0000, v93
v_fmac_f32 v42, v18, v16
v_fmac_f32 v50, v18, v17
v_fmac_f32 v43, v19, v16
v_fmac_f32 v51, v19, v17
v_lshlrev_b32 v18, 16, v94
v_and_b32 v19, 0xffff0000, v94
v_fmac_f32 v44, v18, v16
v_fmac_f32 v52, v18, v17
v_fmac_f32 v45, v19, v16
v_fmac_f32 v53, v19, v17
v_lshlrev_b32 v18, 16, v95
v_and_b32 v19, 0xffff0000, v95
v_fmac_f32 v46, v18, v16
v_fmac_f32 v54, v18, v17
v_fmac_f32 v47, v19, v16
v_fmac_f32 v55, v19, v17
ds_read_b64 v[16:17], v12 offset:2048
s_waitcnt vmcnt(5) lgkmcnt(0)
v_lshlrev_b32 v18, 16, v96
v_and_b32 v19, 0xffff0000, v96
v_fmac_f32 v40, v18, v16
v_fmac_f32 v48, v18, v17
v_fmac_f32 v41, v19, v16
v_fmac_f32 v49, v19, v17
v_lshlrev_b32 v18, 16, v97
v_and_b32 v19, 0xffff0000, v97
v_fmac_f32 v42, v18, v16
v_fmac_f32 v50, v18, v17
v_fmac_f32 v43, v19, v16
v_fmac_f32 v51, v19, v17
v_lshlrev_b32 v18, 16, v98
v_and_b32 v19, 0xffff0000, v98
v_fmac_f32 v44, v18, v16
v_fmac_f32 v52, v18, v17
v_fmac_f32 v45, v19, v16
v_fmac_f32 v53, v19, v17
v_lshlrev_b32 v18, 16, v99
v_and_b32 v19, 0xffff0000, v99
v_fmac_f32 v46, v18, v16
v_fmac_f32 v54, v18, v17
v_fmac_f32 v47, v19, v16
v_fmac_f32 v55, v19, v17
ds_read_b64 v[16:17], v12 offset:2304
s_waitcnt vmcnt(4) lgkmcnt(0)
v_lshlrev_b32 v18, 16, v100
v_and_b32 v19, 0xffff0000, v100
v_fmac_f32 v40, v18, v16
v_fmac_f32 v48, v18, v17
v_fmac_f32 v41, v19, v16
v_fmac_f32 v49, v19, v17
v_lshlrev_b32 v18, 16, v101
v_and_b32 v19, 0xffff0000, v101
v_fmac_f32 v42, v18, v16
v_fmac_f32 v50, v18, v17
v_fmac_f32 v43, v19, v16
v_fmac_f32 v51, v19, v17
v_lshlrev_b32 v18, 16, v102
v_and_b32 v19, 0xffff0000, v102
v_fmac_f32 v44, v18, v16
v_fmac_f32 v52, v18, v17
v_fmac_f32 v45, v19, v16
v_fmac_f32 v53, v19, v17
v_lshlrev_b32 v18, 16, v103
v_and_b32 v19, 0xffff0000, v103
v_fmac_f32 v46, v18, v16
v_fmac_f32 v54, v18, v17
v_fmac_f32 v47, v19, v16
v_fmac_f32 v55, v19, v17
ds_read_b64 v[16:17], v12 offset:2560
s_waitcnt vmcnt(3) lgkmcnt(0)
v_lshlrev_b32 v18, 16, v104
v_and_b32 v19, 0xffff0000, v104
v_fmac_f32 v40, v18, v16
v_fmac_f32 v48, v18, v17
v_fmac_f32 v41, v19, v16
v_fmac_f32 v49, v19, v17
v_lshlrev_b32 v18, 16, v105
v_and_b32 v19, 0xffff0000, v105
v_fmac_f32 v42, v18, v16
v_fmac_f32 v50, v18, v17
v_fmac_f32 v43, v19, v16
v_fmac_f32 v51, v19, v17
v_lshlrev_b32 v18, 16, v106
v_and_b32 v19, 0xffff0000, v106
v_fmac_f32 v44, v18, v16
v_fmac_f32 v52, v18, v17
v_fmac_f32 v45, v19, v16
v_fmac_f32 v53, v19, v17
v_lshlrev_b32 v18, 16, v107
v_and_b32 v19, 0xffff0000, v107
v_fmac_f32 v46, v18, v16
v_fmac_f32 v54, v18, v17
v_fmac_f32 v47, v19, v16
v_fmac_f32 v55, v19, v17
ds_read_b64 v[16:17], v12 offset:2816
s_waitcnt vmcnt(2) lgkmcnt(0)
v_lshlrev_b32 v18, 16, v108
v_and_b32 v19, 0xffff0000, v108
v_fmac_f32 v40, v18, v16
v_fmac_f32 v48, v18, v17
v_fmac_f32 v41, v19, v16
v_fmac_f32 v49, v19, v17
v_lshlrev_b32 v18, 16, v109
v_and_b32 v19, 0xffff0000, v109
v_fmac_f32 v42, v18, v16
v_fmac_f32 v50, v18, v17
v_fmac_f32 v43, v19, v16
v_fmac_f32 v51, v19, v17
v_lshlrev_b32 v18, 16, v110
v_and_b32 v19, 0xffff0000, v110
v_fmac_f32 v44, v18, v16
v_fmac_f32 v52, v18, v17
v_fmac_f32 v45, v19, v16
v_fmac_f32 v53, v19, v17
v_lshlrev_b32 v18, 16, v111
v_and_b32 v19, 0xffff0000, v111
v_fmac_f32 v46, v18, v16
v_fmac_f32 v54, v18, v17
v_fmac_f32 v47, v19, v16
v_fmac_f32 v55, v19, v17
ds_read_b64 v[16:17], v12 offset:3072
s_waitcnt vmcnt(1) lgkmcnt(0)
v_lshlrev_b32 v18, 16, v112
v_and_b32 v19, 0xffff0000, v112
v_fmac_f32 v40, v18, v16
v_fmac_f32 v48, v18, v17
v_fmac_f32 v41, v19, v16
v_fmac_f32 v49, v19, v17
v_lshlrev_b32 v18, 16, v113
v_and_b32 v19, 0xffff0000, v113
v_fmac_f32 v42, v18, v16
v_fmac_f32 v50, v18, v17
v_fmac_f32 v43, v19, v16
v_fmac_f32 v51, v19, v17
v_lshlrev_b32 v18, 16, v114
v_and_b32 v19, 0xffff0000, v114
v_fmac_f32 v44, v18, v16
v_fmac_f32 v52, v18, v17
v_fmac_f32 v45, v19, v16
v_fmac_f32 v53, v19, v17
v_lshlrev_b32 v18, 16, v115
v_and_b32 v19, 0xffff0000, v115
v_fmac_f32 v46, v18, v16
v_fmac_f32 v54, v18, v17
v_fmac_f32 v47, v19, v16
v_fmac_f32 v55, v19, v17
ds_read_b64 v[16:17], v12 offset:3328
s_waitcnt vmcnt(0) lgkmcnt(0)
v_lshlrev_b32 v18, 16, v116
v_and_b32 v19, 0xffff0000, v116
v_fmac_f32 v40, v18, v16
v_fmac_f32 v48, v18, v17
v_fmac_f32 v41, v19, v16
v_fmac_f32 v49, v19, v17
v_lshlrev_b32 v18, 16, v117
v_and_b32 v19, 0xffff0000, v117
v_fmac_f32 v42, v18, v16
v_fmac_f32 v50, v18, v17
v_fmac_f32 v43, v19, v16
v_fmac_f32 v51, v19, v17
v_lshlrev_b32 v18, 16, v118
v_and_b32 v19, 0xffff0000, v118
v_fmac_f32 v44, v18, v16
v_fmac_f32 v52, v18, v17
v_fmac_f32 v45, v19, v16
v_fmac_f32 v53, v19, v17
v_lshlrev_b32 v18, 16, v119
v_and_b32 v19, 0xffff0000, v119
v_fmac_f32 v46, v18, v16
v_fmac_f32 v54, v18, v17
v_fmac_f32 v47, v19, v16
v_fmac_f32 v55, v19, v17
v_lshlrev_b32 v12, 10, v4
v_lshl_add_u32 v12, v3, 5, v12
v_add_u32 v12, 4096, v12
ds_write_b128 v12, v[40:43]
ds_write_b128 v12, v[44:47] offset:16
ds_write_b128 v12, v[48:51] offset:512
ds_write_b128 v12, v[52:55] offset:528
s_waitcnt lgkmcnt(0)
s_barrier
s_cmp_ge_u32 s3, 4
s_cbranch_scc1 ka_kernel_end
v_lshlrev_b32 v12, 2, v0
v_mov_b32 v13, 0
ds_read_b32 v64, v12 offset:4096
ds_read_b32 v65, v12 offset:5120
ds_read_b32 v66, v12 offset:6144
ds_read_b32 v67, v12 offset:7168
ds_read_b32 v68, v12 offset:8192
ds_read_b32 v69, v12 offset:9216
ds_read_b32 v70, v12 offset:10240
ds_read_b32 v71, v12 offset:11264
ds_read_b32 v72, v12 offset:12288
ds_read_b32 v73, v12 offset:13312
ds_read_b32 v74, v12 offset:14336
ds_read_b32 v75, v12 offset:15360
ds_read_b32 v76, v12 offset:16384
ds_read_b32 v77, v12 offset:17408
ds_read_b32 v78, v12 offset:18432
ds_read_b32 v79, v12 offset:19456
ds_read_b32 v80, v12 offset:20480
ds_read_b32 v81, v12 offset:21504
ds_read_b32 v82, v12 offset:22528
ds_read_b32 v83, v12 offset:23552
ds_read_b32 v84, v12 offset:24576
ds_read_b32 v85, v12 offset:25600
ds_read_b32 v86, v12 offset:26624
ds_read_b32 v87, v12 offset:27648
ds_read_b32 v88, v12 offset:28672
ds_read_b32 v89, v12 offset:29696
ds_read_b32 v90, v12 offset:30720
ds_read_b32 v91, v12 offset:31744
ds_read_b32 v92, v12 offset:32768
ds_read_b32 v93, v12 offset:33792
ds_read_b32 v94, v12 offset:34816
ds_read_b32 v95, v12 offset:35840
v_and_b32 v14, 127, v0
s_lshl_b32 s6, s4, 7
v_add_u32 v14, s6, v14
v_lshlrev_b32 v15, 1, v14
global_load_ushort v16, v15, s[32:33]
s_waitcnt lgkmcnt(0)
v_add_f32 v13, v13, v64
v_add_f32 v13, v13, v65
v_add_f32 v13, v13, v66
v_add_f32 v13, v13, v67
v_add_f32 v13, v13, v68
v_add_f32 v13, v13, v69
v_add_f32 v13, v13, v70
v_add_f32 v13, v13, v71
v_add_f32 v13, v13, v72
v_add_f32 v13, v13, v73
v_add_f32 v13, v13, v74
v_add_f32 v13, v13, v75
v_add_f32 v13, v13, v76
v_add_f32 v13, v13, v77
v_add_f32 v13, v13, v78
v_add_f32 v13, v13, v79
v_add_f32 v13, v13, v80
v_add_f32 v13, v13, v81
v_add_f32 v13, v13, v82
v_add_f32 v13, v13, v83
v_add_f32 v13, v13, v84
v_add_f32 v13, v13, v85
v_add_f32 v13, v13, v86
v_add_f32 v13, v13, v87
v_add_f32 v13, v13, v88
v_add_f32 v13, v13, v89
v_add_f32 v13, v13, v90
v_add_f32 v13, v13, v91
v_add_f32 v13, v13, v92
v_add_f32 v13, v13, v93
v_add_f32 v13, v13, v94
v_add_f32 v13, v13, v95
v_cvt_pk_bf16_f32 v17, v13, v13
v_lshlrev_b32 v13, 16, v17
s_waitcnt vmcnt(0)
v_lshlrev_b32 v16, 16, v16
v_add_f32 v13, v13, v16
v_cvt_pk_bf16_f32 v17, v13, v13
v_lshlrev_b32 v13, 16, v17
v_mul_f32 v16, v13, v13
v_mul_f32 v16, 0x3d372713, v16
v_add_f32 v16, 1.0, v16
v_mul_f32 v16, v16, v13
v_mul_f32 v16, 0xc0135761, v16
v_exp_f32 v16, v16
s_nop 0
v_add_f32 v16, 1.0, v16
v_rcp_f32 v16, v16
s_nop 0
v_mul_f32 v13, v13, v16
v_cvt_pk_bf16_f32 v17, v13, v13
v_lshlrev_b32 v13, 16, v17
v_lshrrev_b32 v15, 7, v0
v_mul_u32_u24 v15, 1792, v15
v_add_u32 v15, v15, v14
v_lshlrev_b32 v15, 2, v15
v_add_u32 v15, 65536, v15
global_store_dword v15, v13, s[40:41]
ka_kernel_end:
s_endpgm
.section .rodata,"a"
.p2align 6
.amdhsa_kernel ka_kernel
  .amdhsa_next_free_vgpr 128
  .amdhsa_next_free_sgpr 96
  .amdhsa_accum_offset 128
  .amdhsa_group_segment_fixed_size 0
  .amdhsa_kernarg_size 112
  .amdhsa_user_sgpr_count 2
  .amdhsa_user_sgpr_kernarg_segment_ptr 1
  .amdhsa_system_sgpr_workgroup_id_x 1
.end_amdhsa_kernel
.text
.globl kb_kernel
.p2align 8
.type kb_kernel,@function
kb_kernel:
s_cmp_ge_u32 s2, 284
s_cbranch_scc1 kb_kernel_end
s_load_dwordx16 s[16:31], s[0:1], 0
s_load_dwordx8 s[32:39], s[0:1], 64
s_load_dwordx2 s[40:41], s[0:1], 104
s_waitcnt lgkmcnt(0)
v_and_b32 v1, 63, v0
v_lshrrev_b32 v2, 6, v0
s_nop 0
v_readfirstlane_b32 s3, v2
s_cmp_ge_u32 s2, 256
s_cbranch_scc1 kb_ffn
s_lshr_b32 s4, s2, 7
s_and_b32 s5, s2, 127
v_and_b32 v3, 15, v1
v_lshrrev_b32 v4, 4, v1
s_lshl_b32 s6, s4, 23
s_lshl_b32 s7, s5, 16
s_add_u32 s6, s6, s7
s_lshl_b32 s7, s3, 9
s_add_u32 s6, s6, s7
v_lshlrev_b32 v5, 11, v3
v_lshl_add_u32 v5, v4, 4, v5
v_add_u32 v5, s6, v5
v_add_u32 v6, 0x8000, v5
global_load_dwordx4 v[64:67], v5, s[18:19] offset:0
global_load_dwordx4 v[68:71], v5, s[18:19] offset:64
global_load_dwordx4 v[72:75], v5, s[18:19] offset:128
global_load_dwordx4 v[76:79], v5, s[18:19] offset:192
global_load_dwordx4 v[80:83], v5, s[18:19] offset:256
global_load_dwordx4 v[84:87], v5, s[18:19] offset:320
global_load_dwordx4 v[88:91], v5, s[18:19] offset:384
global_load_dwordx4 v[92:95], v5, s[18:19] offset:448
global_load_dwordx4 v[96:99], v6, s[18:19] offset:0
global_load_dwordx4 v[100:103], v6, s[18:19] offset:64
global_load_dwordx4 v[104:107], v6, s[18:19] offset:128
global_load_dwordx4 v[108:111], v6, s[18:19] offset:192
global_load_dwordx4 v[112:115], v6, s[18:19] offset:256
global_load_dwordx4 v[116:119], v6, s[18:19] offset:320
global_load_dwordx4 v[120:123], v6, s[18:19] offset:384
global_load_dwordx4 v[124:127], v6, s[18:19] offset:448
s_lshl_b32 s8, s4, 15
s_add_u32 s8, s8, s7
v_lshlrev_b32 v7, 11, v3
v_lshl_add_u32 v7, v4, 4, v7
v_add_u32 v7, s8, v7
global_load_dwordx4 v[128:131], v7, s[40:41] offset:0
global_load_dwordx4 v[132:135], v7, s[40:41] offset:64
global_load_dwordx4 v[136:139], v7, s[40:41] offset:128
global_load_dwordx4 v[140:143], v7, s[40:41] offset:192
global_load_dwordx4 v[144:147], v7, s[40:41] offset:256
global_load_dwordx4 v[148:151], v7, s[40:41] offset:320
global_load_dwordx4 v[152:155], v7, s[40:41] offset:384
global_load_dwordx4 v[156:159], v7, s[40:41] offset:448
v_mov_b32 v40, 0
v_mov_b32 v41, 0
v_mov_b32 v42, 0
v_mov_b32 v43, 0
v_mov_b32 v44, 0
v_mov_b32 v45, 0
v_mov_b32 v46, 0
v_mov_b32 v47, 0
v_mul_u32_u24 v8, 2064, v3
v_lshl_add_u32 v8, v4, 4, v8
v_add_u32 v8, s7, v8
s_waitcnt vmcnt(8)
ds_write_b128 v8, v[64:67] offset:0
ds_write_b128 v8, v[96:99] offset:33024
ds_write_b128 v8, v[68:71] offset:64
ds_write_b128 v8, v[100:103] offset:33088
ds_write_b128 v8, v[72:75] offset:128
ds_write_b128 v8, v[104:107] offset:33152
ds_write_b128 v8, v[76:79] offset:192
ds_write_b128 v8, v[108:111] offset:33216
ds_write_b128 v8, v[80:83] offset:256
ds_write_b128 v8, v[112:115] offset:33280
ds_write_b128 v8, v[84:87] offset:320
ds_write_b128 v8, v[116:119] offset:33344
ds_write_b128 v8, v[88:91] offset:384
ds_write_b128 v8, v[120:123] offset:33408
ds_write_b128 v8, v[92:95] offset:448
ds_write_b128 v8, v[124:127] offset:33472
s_waitcnt vmcnt(0)
v_mfma_f32_16x16x32_bf16 v[40:43], v[64:67], v[128:131], v[40:43]
v_mfma_f32_16x16x32_bf16 v[44:47], v[96:99], v[128:131], v[44:47]
v_mfma_f32_16x16x32_bf16 v[40:43], v[68:71], v[132:135], v[40:43]
v_mfma_f32_16x16x32_bf16 v[44:47], v[100:103], v[132:135], v[44:47]
v_mfma_f32_16x16x32_bf16 v[40:43], v[72:75], v[136:139], v[40:43]
v_mfma_f32_16x16x32_bf16 v[44:47], v[104:107], v[136:139], v[44:47]
v_mfma_f32_16x16x32_bf16 v[40:43], v[76:79], v[140:143], v[40:43]
v_mfma_f32_16x16x32_bf16 v[44:47], v[108:111], v[140:143], v[44:47]
v_mfma_f32_16x16x32_bf16 v[40:43], v[80:83], v[144:147], v[40:43]
v_mfma_f32_16x16x32_bf16 v[44:47], v[112:115], v[144:147], v[44:47]
v_mfma_f32_16x16x32_bf16 v[40:43], v[84:87], v[148:151], v[40:43]
v_mfma_f32_16x16x32_bf16 v[44:47], v[116:119], v[148:151], v[44:47]
v_mfma_f32_16x16x32_bf16 v[40:43], v[88:91], v[152:155], v[40:43]
v_mfma_f32_16x16x32_bf16 v[44:47], v[120:123], v[152:155], v[44:47]
v_mfma_f32_16x16x32_bf16 v[40:43], v[92:95], v[156:159], v[40:43]
v_mfma_f32_16x16x32_bf16 v[44:47], v[124:127], v[156:159], v[44:47]
s_nop 15
v_lshlrev_b32 v9, 5, v1
v_add_u32 v9, 66048, v9
s_lshl_b32 s9, s3, 11
v_add_u32 v15, s9, v9
ds_write_b128 v15, v[40:43]
ds_write_b128 v15, v[44:47] offset:16
s_waitcnt lgkmcnt(0)
s_barrier
ds_read_b128 v[160:163], v9 offset:0
ds_read_b128 v[164:167], v9 offset:16
ds_read_b128 v[168:171], v9 offset:2048
ds_read_b128 v[172:175], v9 offset:2064
ds_read_b128 v[176:179], v9 offset:4096
ds_read_b128 v[180:183], v9 offset:4112
ds_read_b128 v[184:187], v9 offset:6144
ds_read_b128 v[188:191], v9 offset:6160
s_waitcnt lgkmcnt(0)
v_add_f32 v40, v160, v168
v_add_f32 v40, v40, v176
v_add_f32 v40, v40, v184
v_add_f32 v41, v161, v169
v_add_f32 v41, v41, v177
v_add_f32 v41, v41, v185
v_add_f32 v42, v162, v170
v_add_f32 v42, v42, v178
v_add_f32 v42, v42, v186
v_add_f32 v43, v163, v171
v_add_f32 v43, v43, v179
v_add_f32 v43, v43, v187
v_add_f32 v44, v164, v172
v_add_f32 v44, v44, v180
v_add_f32 v44, v44, v188
v_add_f32 v45, v165, v173
v_add_f32 v45, v45, v181
v_add_f32 v45, v45, v189
v_add_f32 v46, v166, v174
v_add_f32 v46, v46, v182
v_add_f32 v46, v46, v190
v_add_f32 v47, v167, v175
v_add_f32 v47, v47, v183
v_add_f32 v47, v47, v191
v_max_f32 v10, v40, v41
v_max_f32 v10, v10, v42
v_max_f32 v10, v10, v43
v_max_f32 v10, v10, v44
v_max_f32 v10, v10, v45
v_max_f32 v10, v10, v46
v_max_f32 v10, v10, v47
v_xor_b32 v11, 16, v1
v_lshlrev_b32 v11, 2, v11
ds_bpermute_b32 v11, v11, v10
s_waitcnt lgkmcnt(0)
v_max_f32 v10, v10, v11
v_xor_b32 v11, 32, v1
v_lshlrev_b32 v11, 2, v11
ds_bpermute_b32 v11, v11, v10
s_waitcnt lgkmcnt(0)
v_max_f32 v10, v10, v11
v_mov_b32 v12, 0
v_sub_f32 v40, v40, v10
v_mul_f32 v40, 0x3db8aa3b, v40
v_exp_f32 v40, v40
s_nop 0
v_add_f32 v12, v12, v40
v_sub_f32 v41, v41, v10
v_mul_f32 v41, 0x3db8aa3b, v41
v_exp_f32 v41, v41
s_nop 0
v_add_f32 v12, v12, v41
v_sub_f32 v42, v42, v10
v_mul_f32 v42, 0x3db8aa3b, v42
v_exp_f32 v42, v42
s_nop 0
v_add_f32 v12, v12, v42
v_sub_f32 v43, v43, v10
v_mul_f32 v43, 0x3db8aa3b, v43
v_exp_f32 v43, v43
s_nop 0
v_add_f32 v12, v12, v43
v_sub_f32 v44, v44, v10
v_mul_f32 v44, 0x3db8aa3b, v44
v_exp_f32 v44, v44
s_nop 0
v_add_f32 v12, v12, v44
v_sub_f32 v45, v45, v10
v_mul_f32 v45, 0x3db8aa3b, v45
v_exp_f32 v45, v45
s_nop 0
v_add_f32 v12, v12, v45
v_sub_f32 v46, v46, v10
v_mul_f32 v46, 0x3db8aa3b, v46
v_exp_f32 v46, v46
s_nop 0
v_add_f32 v12, v12, v46
v_sub_f32 v47, v47, v10
v_mul_f32 v47, 0x3db8aa3b, v47
v_exp_f32 v47, v47
s_nop 0
v_add_f32 v12, v12, v47
v_xor_b32 v11, 16, v1
v_lshlrev_b32 v11, 2, v11
ds_bpermute_b32 v11, v11, v12
s_waitcnt lgkmcnt(0)
v_add_f32 v12, v12, v11
v_xor_b32 v11, 32, v1
v_lshlrev_b32 v11, 2, v11
ds_bpermute_b32 v11, v11, v12
s_waitcnt lgkmcnt(0)
v_add_f32 v12, v12, v11
v_cvt_pk_bf16_f32 v48, v40, v41
v_cvt_pk_bf16_f32 v49, v42, v43
v_cvt_pk_bf16_f32 v50, v44, v45
v_cvt_pk_bf16_f32 v51, v46, v47
s_lshl_b32 s10, s2, 6
v_lshl_add_u32 v13, v1, 2, s10
v_add_u32 v14, 131072, v13
v_add_u32 v13, 147456, v13
s_cmp_lg_u32 s3, 0
s_cbranch_scc1 kb_nost
v_cmp_gt_u32 vcc, 16, v1
s_and_saveexec_b64 s[12:13], vcc
global_store_dword v14, v10, s[40:41]
global_store_dword v13, v12, s[40:41]
s_mov_b64 exec, s[12:13]
kb_nost:
v_lshrrev_b32 v13, 2, v3
v_lshl_add_u32 v13, v4, 2, v13
v_mul_u32_u24 v13, 2064, v13
v_and_b32 v14, 3, v3
v_lshl_add_u32 v13, v14, 3, v13
v_add_u32 v13, s7, v13
ds_read_b64_tr_b16 v[64:65], v13 offset:0
ds_read_b64_tr_b16 v[66:67], v13 offset:33024
ds_read_b64_tr_b16 v[68:69], v13 offset:32
ds_read_b64_tr_b16 v[70:71], v13 offset:33056
ds_read_b64_tr_b16 v[72:73], v13 offset:64
ds_read_b64_tr_b16 v[74:75], v13 offset:33088
ds_read_b64_tr_b16 v[76:77], v13 offset:96
ds_read_b64_tr_b16 v[78:79], v13 offset:33120
ds_read_b64_tr_b16 v[80:81], v13 offset:128
ds_read_b64_tr_b16 v[82:83], v13 offset:33152
ds_read_b64_tr_b16 v[84:85], v13 offset:160
ds_read_b64_tr_b16 v[86:87], v13 offset:33184
ds_read_b64_tr_b16 v[88:89], v13 offset:192
ds_read_b64_tr_b16 v[90:91], v13 offset:33216
ds_read_b64_tr_b16 v[92:93], v13 offset:224
ds_read_b64_tr_b16 v[94:95], v13 offset:33248
ds_read_b64_tr_b16 v[96:97], v13 offset:256
ds_read_b64_tr_b16 v[98:99], v13 offset:33280
ds_read_b64_tr_b16 v[100:101], v13 offset:288
ds_read_b64_tr_b16 v[102:103], v13 offset:33312
ds_read_b64_tr_b16 v[104:105], v13 offset:320
ds_read_b64_tr_b16 v[106:107], v13 offset:33344
ds_read_b64_tr_b16 v[108:109], v13 offset:352
ds_read_b64_tr_b16 v[110:111], v13 offset:33376
ds_read_b64_tr_b16 v[112:113], v13 offset:384
ds_read_b64_tr_b16 v[114:115], v13 offset:33408
ds_read_b64_tr_b16 v[116:117], v13 offset:416
ds_read_b64_tr_b16 v[118:119], v13 offset:33440
ds_read_b64_tr_b16 v[120:121], v13 offset:448
ds_read_b64_tr_b16 v[122:123], v13 offset:33472
ds_read_b64_tr_b16 v[124:125], v13 offset:480
ds_read_b64_tr_b16 v[126:127], v13 offset:33504
s_waitcnt lgkmcnt(0)
v_mfma_f32_16x16x32_bf16 v[128:131], v[64:67], v[48:51], 0
v_mfma_f32_16x16x32_bf16 v[132:135], v[68:71], v[48:51], 0
v_mfma_f32_16x16x32_bf16 v[136:139], v[72:75], v[48:51], 0
v_mfma_f32_16x16x32_bf16 v[140:143], v[76:79], v[48:51], 0
v_mfma_f32_16x16x32_bf16 v[144:147], v[80:83], v[48:51], 0
v_mfma_f32_16x16x32_bf16 v[148:151], v[84:87], v[48:51], 0
v_mfma_f32_16x16x32_bf16 v[152:155], v[88:91], v[48:51], 0
v_mfma_f32_16x16x32_bf16 v[156:159], v[92:95], v[48:51], 0
v_mfma_f32_16x16x32_bf16 v[160:163], v[96:99], v[48:51], 0
v_mfma_f32_16x16x32_bf16 v[164:167], v[100:103], v[48:51], 0
v_mfma_f32_16x16x32_bf16 v[168:171], v[104:107], v[48:51], 0
v_mfma_f32_16x16x32_bf16 v[172:175], v[108:111], v[48:51], 0
v_mfma_f32_16x16x32_bf16 v[176:179], v[112:115], v[48:51], 0
v_mfma_f32_16x16x32_bf16 v[180:183], v[116:119], v[48:51], 0
v_mfma_f32_16x16x32_bf16 v[184:187], v[120:123], v[48:51], 0
v_mfma_f32_16x16x32_bf16 v[188:191], v[124:127], v[48:51], 0
s_nop 15
s_lshl_b32 s10, s2, 15
s_add_u32 s10, s10, s7
s_add_u32 s10, s10, 1048576
v_lshlrev_b32 v13, 11, v3
v_lshl_add_u32 v13, v4, 3, v13
v_add_u32 v13, s10, v13
v_cvt_pk_bf16_f32 v128, v128, v129
v_cvt_pk_bf16_f32 v129, v130, v131
global_store_dwordx2 v13, v[128:129], s[40:41] offset:0
v_cvt_pk_bf16_f32 v132, v132, v133
v_cvt_pk_bf16_f32 v133, v134, v135
global_store_dwordx2 v13, v[132:133], s[40:41] offset:32
v_cvt_pk_bf16_f32 v136, v136, v137
v_cvt_pk_bf16_f32 v137, v138, v139
global_store_dwordx2 v13, v[136:137], s[40:41] offset:64
v_cvt_pk_bf16_f32 v140, v140, v141
v_cvt_pk_bf16_f32 v141, v142, v143
global_store_dwordx2 v13, v[140:141], s[40:41] offset:96
v_cvt_pk_bf16_f32 v144, v144, v145
v_cvt_pk_bf16_f32 v145, v146, v147
global_store_dwordx2 v13, v[144:145], s[40:41] offset:128
v_cvt_pk_bf16_f32 v148, v148, v149
v_cvt_pk_bf16_f32 v149, v150, v151
global_store_dwordx2 v13, v[148:149], s[40:41] offset:160
v_cvt_pk_bf16_f32 v152, v152, v153
v_cvt_pk_bf16_f32 v153, v154, v155
global_store_dwordx2 v13, v[152:153], s[40:41] offset:192
v_cvt_pk_bf16_f32 v156, v156, v157
v_cvt_pk_bf16_f32 v157, v158, v159
global_store_dwordx2 v13, v[156:157], s[40:41] offset:224
v_cvt_pk_bf16_f32 v160, v160, v161
v_cvt_pk_bf16_f32 v161, v162, v163
global_store_dwordx2 v13, v[160:161], s[40:41] offset:256
v_cvt_pk_bf16_f32 v164, v164, v165
v_cvt_pk_bf16_f32 v165, v166, v167
global_store_dwordx2 v13, v[164:165], s[40:41] offset:288
v_cvt_pk_bf16_f32 v168, v168, v169
v_cvt_pk_bf16_f32 v169, v170, v171
global_store_dwordx2 v13, v[168:169], s[40:41] offset:320
v_cvt_pk_bf16_f32 v172, v172, v173
v_cvt_pk_bf16_f32 v173, v174, v175
global_store_dwordx2 v13, v[172:173], s[40:41] offset:352
v_cvt_pk_bf16_f32 v176, v176, v177
v_cvt_pk_bf16_f32 v177, v178, v179
global_store_dwordx2 v13, v[176:177], s[40:41] offset:384
v_cvt_pk_bf16_f32 v180, v180, v181
v_cvt_pk_bf16_f32 v181, v182, v183
global_store_dwordx2 v13, v[180:181], s[40:41] offset:416
v_cvt_pk_bf16_f32 v184, v184, v185
v_cvt_pk_bf16_f32 v185, v186, v187
global_store_dwordx2 v13, v[184:185], s[40:41] offset:448
v_cvt_pk_bf16_f32 v188, v188, v189
v_cvt_pk_bf16_f32 v189, v190, v191
global_store_dwordx2 v13, v[188:189], s[40:41] offset:480
s_branch kb_kernel_end
kb_ffn:
s_sub_u32 s4, s2, 256
v_cmp_gt_u32 vcc, 224, v0
s_and_saveexec_b64 s[12:13], vcc
v_mul_u32_u24 v4, 1171, v0
v_lshrrev_b32 v4, 16, v4
v_mul_u32_u24 v3, 56, v4
v_sub_u32 v3, v0, v3
s_mul_i32 s6, s4, 64*896
v_mul_u32_u24 v5, 896, v4
v_lshl_add_u32 v5, v3, 4, v5
v_add_u32 v5, s6, v5
global_load_dwordx4 v[64:67], v5, s[34:35]
v_add_u32 v5, 3584, v5
global_load_dwordx4 v[68:71], v5, s[34:35]
v_add_u32 v5, 3584, v5
global_load_dwordx4 v[72:75], v5, s[34:35]
v_add_u32 v5, 3584, v5
global_load_dwordx4 v[76:79], v5, s[34:35]
v_add_u32 v5, 3584, v5
global_load_dwordx4 v[80:83], v5, s[34:35]
v_add_u32 v5, 3584, v5
global_load_dwordx4 v[84:87], v5, s[34:35]
v_add_u32 v5, 3584, v5
global_load_dwordx4 v[88:91], v5, s[34:35]
v_add_u32 v5, 3584, v5
global_load_dwordx4 v[92:95], v5, s[34:35]
v_add_u32 v5, 3584, v5
global_load_dwordx4 v[96:99], v5, s[34:35]
v_add_u32 v5, 3584, v5
global_load_dwordx4 v[100:103], v5, s[34:35]
v_add_u32 v5, 3584, v5
global_load_dwordx4 v[104:107], v5, s[34:35]
v_add_u32 v5, 3584, v5
global_load_dwordx4 v[108:111], v5, s[34:35]
v_add_u32 v5, 3584, v5
global_load_dwordx4 v[112:115], v5, s[34:35]
v_add_u32 v5, 3584, v5
global_load_dwordx4 v[116:119], v5, s[34:35]
v_add_u32 v5, 3584, v5
global_load_dwordx4 v[120:123], v5, s[34:35]
v_add_u32 v5, 3584, v5
global_load_dwordx4 v[124:127], v5, s[34:35]
s_mov_b64 exec, s[12:13]
v_cmp_gt_u32 vcc, 128, v0
s_and_saveexec_b64 s[14:15], vcc
v_and_b32 v6, 63, v0
s_lshl_b32 s6, s4, 6
v_add_u32 v6, s6, v6
v_lshrrev_b32 v7, 6, v0
v_mul_u32_u24 v8, 1792, v7
v_add_u32 v8, v8, v6
v_lshlrev_b32 v8, 2, v8
v_add_u32 v8, 65536, v8
global_load_dword v9, v8, s[40:41]
v_and_b32 v6, 63, v0
v_lshlrev_b32 v6, 3, v6
v_lshl_add_u32 v6, v7, 2, v6
s_waitcnt vmcnt(0)
ds_write_b32 v6, v9
s_mov_b64 exec, s[14:15]
s_waitcnt lgkmcnt(0)
s_barrier
v_cmp_gt_u32 vcc, 224, v0
s_and_saveexec_b64 s[12:13], vcc
v_mov_b32 v40, 0
v_mov_b32 v41, 0
v_mov_b32 v42, 0
v_mov_b32 v43, 0
v_mov_b32 v44, 0
v_mov_b32 v45, 0
v_mov_b32 v46, 0
v_mov_b32 v47, 0
v_mov_b32 v48, 0
v_mov_b32 v49, 0
v_mov_b32 v50, 0
v_mov_b32 v51, 0
v_mov_b32 v52, 0
v_mov_b32 v53, 0
v_mov_b32 v54, 0
v_mov_b32 v55, 0
v_lshlrev_b32 v12, 3, v4
ds_read_b64 v[16:17], v12 offset:0
s_waitcnt vmcnt(15) lgkmcnt(0)
v_lshlrev_b32 v18, 16, v64
v_and_b32 v19, 0xffff0000, v64
v_fmac_f32 v40, v18, v16
v_fmac_f32 v48, v18, v17
v_fmac_f32 v41, v19, v16
v_fmac_f32 v49, v19, v17
v_lshlrev_b32 v18, 16, v65
v_and_b32 v19, 0xffff0000, v65
v_fmac_f32 v42, v18, v16
v_fmac_f32 v50, v18, v17
v_fmac_f32 v43, v19, v16
v_fmac_f32 v51, v19, v17
v_lshlrev_b32 v18, 16, v66
v_and_b32 v19, 0xffff0000, v66
v_fmac_f32 v44, v18, v16
v_fmac_f32 v52, v18, v17
v_fmac_f32 v45, v19, v16
v_fmac_f32 v53, v19, v17
v_lshlrev_b32 v18, 16, v67
v_and_b32 v19, 0xffff0000, v67
v_fmac_f32 v46, v18, v16
v_fmac_f32 v54, v18, v17
v_fmac_f32 v47, v19, v16
v_fmac_f32 v55, v19, v17
ds_read_b64 v[16:17], v12 offset:32
s_waitcnt vmcnt(14) lgkmcnt(0)
v_lshlrev_b32 v18, 16, v68
v_and_b32 v19, 0xffff0000, v68
v_fmac_f32 v40, v18, v16
v_fmac_f32 v48, v18, v17
v_fmac_f32 v41, v19, v16
v_fmac_f32 v49, v19, v17
v_lshlrev_b32 v18, 16, v69
v_and_b32 v19, 0xffff0000, v69
v_fmac_f32 v42, v18, v16
v_fmac_f32 v50, v18, v17
v_fmac_f32 v43, v19, v16
v_fmac_f32 v51, v19, v17
v_lshlrev_b32 v18, 16, v70
v_and_b32 v19, 0xffff0000, v70
v_fmac_f32 v44, v18, v16
v_fmac_f32 v52, v18, v17
v_fmac_f32 v45, v19, v16
v_fmac_f32 v53, v19, v17
v_lshlrev_b32 v18, 16, v71
v_and_b32 v19, 0xffff0000, v71
v_fmac_f32 v46, v18, v16
v_fmac_f32 v54, v18, v17
v_fmac_f32 v47, v19, v16
v_fmac_f32 v55, v19, v17
ds_read_b64 v[16:17], v12 offset:64
s_waitcnt vmcnt(13) lgkmcnt(0)
v_lshlrev_b32 v18, 16, v72
v_and_b32 v19, 0xffff0000, v72
v_fmac_f32 v40, v18, v16
v_fmac_f32 v48, v18, v17
v_fmac_f32 v41, v19, v16
v_fmac_f32 v49, v19, v17
v_lshlrev_b32 v18, 16, v73
v_and_b32 v19, 0xffff0000, v73
v_fmac_f32 v42, v18, v16
v_fmac_f32 v50, v18, v17
v_fmac_f32 v43, v19, v16
v_fmac_f32 v51, v19, v17
v_lshlrev_b32 v18, 16, v74
v_and_b32 v19, 0xffff0000, v74
v_fmac_f32 v44, v18, v16
v_fmac_f32 v52, v18, v17
v_fmac_f32 v45, v19, v16
v_fmac_f32 v53, v19, v17
v_lshlrev_b32 v18, 16, v75
v_and_b32 v19, 0xffff0000, v75
v_fmac_f32 v46, v18, v16
v_fmac_f32 v54, v18, v17
v_fmac_f32 v47, v19, v16
v_fmac_f32 v55, v19, v17
ds_read_b64 v[16:17], v12 offset:96
s_waitcnt vmcnt(12) lgkmcnt(0)
v_lshlrev_b32 v18, 16, v76
v_and_b32 v19, 0xffff0000, v76
v_fmac_f32 v40, v18, v16
v_fmac_f32 v48, v18, v17
v_fmac_f32 v41, v19, v16
v_fmac_f32 v49, v19, v17
v_lshlrev_b32 v18, 16, v77
v_and_b32 v19, 0xffff0000, v77
v_fmac_f32 v42, v18, v16
v_fmac_f32 v50, v18, v17
v_fmac_f32 v43, v19, v16
v_fmac_f32 v51, v19, v17
v_lshlrev_b32 v18, 16, v78
v_and_b32 v19, 0xffff0000, v78
v_fmac_f32 v44, v18, v16
v_fmac_f32 v52, v18, v17
v_fmac_f32 v45, v19, v16
v_fmac_f32 v53, v19, v17
v_lshlrev_b32 v18, 16, v79
v_and_b32 v19, 0xffff0000, v79
v_fmac_f32 v46, v18, v16
v_fmac_f32 v54, v18, v17
v_fmac_f32 v47, v19, v16
v_fmac_f32 v55, v19, v17
ds_read_b64 v[16:17], v12 offset:128
s_waitcnt vmcnt(11) lgkmcnt(0)
v_lshlrev_b32 v18, 16, v80
v_and_b32 v19, 0xffff0000, v80
v_fmac_f32 v40, v18, v16
v_fmac_f32 v48, v18, v17
v_fmac_f32 v41, v19, v16
v_fmac_f32 v49, v19, v17
v_lshlrev_b32 v18, 16, v81
v_and_b32 v19, 0xffff0000, v81
v_fmac_f32 v42, v18, v16
v_fmac_f32 v50, v18, v17
v_fmac_f32 v43, v19, v16
v_fmac_f32 v51, v19, v17
v_lshlrev_b32 v18, 16, v82
v_and_b32 v19, 0xffff0000, v82
v_fmac_f32 v44, v18, v16
v_fmac_f32 v52, v18, v17
v_fmac_f32 v45, v19, v16
v_fmac_f32 v53, v19, v17
v_lshlrev_b32 v18, 16, v83
v_and_b32 v19, 0xffff0000, v83
v_fmac_f32 v46, v18, v16
v_fmac_f32 v54, v18, v17
v_fmac_f32 v47, v19, v16
v_fmac_f32 v55, v19, v17
ds_read_b64 v[16:17], v12 offset:160
s_waitcnt vmcnt(10) lgkmcnt(0)
v_lshlrev_b32 v18, 16, v84
v_and_b32 v19, 0xffff0000, v84
v_fmac_f32 v40, v18, v16
v_fmac_f32 v48, v18, v17
v_fmac_f32 v41, v19, v16
v_fmac_f32 v49, v19, v17
v_lshlrev_b32 v18, 16, v85
v_and_b32 v19, 0xffff0000, v85
v_fmac_f32 v42, v18, v16
v_fmac_f32 v50, v18, v17
v_fmac_f32 v43, v19, v16
v_fmac_f32 v51, v19, v17
v_lshlrev_b32 v18, 16, v86
v_and_b32 v19, 0xffff0000, v86
v_fmac_f32 v44, v18, v16
v_fmac_f32 v52, v18, v17
v_fmac_f32 v45, v19, v16
v_fmac_f32 v53, v19, v17
v_lshlrev_b32 v18, 16, v87
v_and_b32 v19, 0xffff0000, v87
v_fmac_f32 v46, v18, v16
v_fmac_f32 v54, v18, v17
v_fmac_f32 v47, v19, v16
v_fmac_f32 v55, v19, v17
ds_read_b64 v[16:17], v12 offset:192
s_waitcnt vmcnt(9) lgkmcnt(0)
v_lshlrev_b32 v18, 16, v88
v_and_b32 v19, 0xffff0000, v88
v_fmac_f32 v40, v18, v16
v_fmac_f32 v48, v18, v17
v_fmac_f32 v41, v19, v16
v_fmac_f32 v49, v19, v17
v_lshlrev_b32 v18, 16, v89
v_and_b32 v19, 0xffff0000, v89
v_fmac_f32 v42, v18, v16
v_fmac_f32 v50, v18, v17
v_fmac_f32 v43, v19, v16
v_fmac_f32 v51, v19, v17
v_lshlrev_b32 v18, 16, v90
v_and_b32 v19, 0xffff0000, v90
v_fmac_f32 v44, v18, v16
v_fmac_f32 v52, v18, v17
v_fmac_f32 v45, v19, v16
v_fmac_f32 v53, v19, v17
v_lshlrev_b32 v18, 16, v91
v_and_b32 v19, 0xffff0000, v91
v_fmac_f32 v46, v18, v16
v_fmac_f32 v54, v18, v17
v_fmac_f32 v47, v19, v16
v_fmac_f32 v55, v19, v17
ds_read_b64 v[16:17], v12 offset:224
s_waitcnt vmcnt(8) lgkmcnt(0)
v_lshlrev_b32 v18, 16, v92
v_and_b32 v19, 0xffff0000, v92
v_fmac_f32 v40, v18, v16
v_fmac_f32 v48, v18, v17
v_fmac_f32 v41, v19, v16
v_fmac_f32 v49, v19, v17
v_lshlrev_b32 v18, 16, v93
v_and_b32 v19, 0xffff0000, v93
v_fmac_f32 v42, v18, v16
v_fmac_f32 v50, v18, v17
v_fmac_f32 v43, v19, v16
v_fmac_f32 v51, v19, v17
v_lshlrev_b32 v18, 16, v94
v_and_b32 v19, 0xffff0000, v94
v_fmac_f32 v44, v18, v16
v_fmac_f32 v52, v18, v17
v_fmac_f32 v45, v19, v16
v_fmac_f32 v53, v19, v17
v_lshlrev_b32 v18, 16, v95
v_and_b32 v19, 0xffff0000, v95
v_fmac_f32 v46, v18, v16
v_fmac_f32 v54, v18, v17
v_fmac_f32 v47, v19, v16
v_fmac_f32 v55, v19, v17
ds_read_b64 v[16:17], v12 offset:256
s_waitcnt vmcnt(7) lgkmcnt(0)
v_lshlrev_b32 v18, 16, v96
v_and_b32 v19, 0xffff0000, v96
v_fmac_f32 v40, v18, v16
v_fmac_f32 v48, v18, v17
v_fmac_f32 v41, v19, v16
v_fmac_f32 v49, v19, v17
v_lshlrev_b32 v18, 16, v97
v_and_b32 v19, 0xffff0000, v97
v_fmac_f32 v42, v18, v16
v_fmac_f32 v50, v18, v17
v_fmac_f32 v43, v19, v16
v_fmac_f32 v51, v19, v17
v_lshlrev_b32 v18, 16, v98
v_and_b32 v19, 0xffff0000, v98
v_fmac_f32 v44, v18, v16
v_fmac_f32 v52, v18, v17
v_fmac_f32 v45, v19, v16
v_fmac_f32 v53, v19, v17
v_lshlrev_b32 v18, 16, v99
v_and_b32 v19, 0xffff0000, v99
v_fmac_f32 v46, v18, v16
v_fmac_f32 v54, v18, v17
v_fmac_f32 v47, v19, v16
v_fmac_f32 v55, v19, v17
ds_read_b64 v[16:17], v12 offset:288
s_waitcnt vmcnt(6) lgkmcnt(0)
v_lshlrev_b32 v18, 16, v100
v_and_b32 v19, 0xffff0000, v100
v_fmac_f32 v40, v18, v16
v_fmac_f32 v48, v18, v17
v_fmac_f32 v41, v19, v16
v_fmac_f32 v49, v19, v17
v_lshlrev_b32 v18, 16, v101
v_and_b32 v19, 0xffff0000, v101
v_fmac_f32 v42, v18, v16
v_fmac_f32 v50, v18, v17
v_fmac_f32 v43, v19, v16
v_fmac_f32 v51, v19, v17
v_lshlrev_b32 v18, 16, v102
v_and_b32 v19, 0xffff0000, v102
v_fmac_f32 v44, v18, v16
v_fmac_f32 v52, v18, v17
v_fmac_f32 v45, v19, v16
v_fmac_f32 v53, v19, v17
v_lshlrev_b32 v18, 16, v103
v_and_b32 v19, 0xffff0000, v103
v_fmac_f32 v46, v18, v16
v_fmac_f32 v54, v18, v17
v_fmac_f32 v47, v19, v16
v_fmac_f32 v55, v19, v17
ds_read_b64 v[16:17], v12 offset:320
s_waitcnt vmcnt(5) lgkmcnt(0)
v_lshlrev_b32 v18, 16, v104
v_and_b32 v19, 0xffff0000, v104
v_fmac_f32 v40, v18, v16
v_fmac_f32 v48, v18, v17
v_fmac_f32 v41, v19, v16
v_fmac_f32 v49, v19, v17
v_lshlrev_b32 v18, 16, v105
v_and_b32 v19, 0xffff0000, v105
v_fmac_f32 v42, v18, v16
v_fmac_f32 v50, v18, v17
v_fmac_f32 v43, v19, v16
v_fmac_f32 v51, v19, v17
v_lshlrev_b32 v18, 16, v106
v_and_b32 v19, 0xffff0000, v106
v_fmac_f32 v44, v18, v16
v_fmac_f32 v52, v18, v17
v_fmac_f32 v45, v19, v16
v_fmac_f32 v53, v19, v17
v_lshlrev_b32 v18, 16, v107
v_and_b32 v19, 0xffff0000, v107
v_fmac_f32 v46, v18, v16
v_fmac_f32 v54, v18, v17
v_fmac_f32 v47, v19, v16
v_fmac_f32 v55, v19, v17
ds_read_b64 v[16:17], v12 offset:352
s_waitcnt vmcnt(4) lgkmcnt(0)
v_lshlrev_b32 v18, 16, v108
v_and_b32 v19, 0xffff0000, v108
v_fmac_f32 v40, v18, v16
v_fmac_f32 v48, v18, v17
v_fmac_f32 v41, v19, v16
v_fmac_f32 v49, v19, v17
v_lshlrev_b32 v18, 16, v109
v_and_b32 v19, 0xffff0000, v109
v_fmac_f32 v42, v18, v16
v_fmac_f32 v50, v18, v17
v_fmac_f32 v43, v19, v16
v_fmac_f32 v51, v19, v17
v_lshlrev_b32 v18, 16, v110
v_and_b32 v19, 0xffff0000, v110
v_fmac_f32 v44, v18, v16
v_fmac_f32 v52, v18, v17
v_fmac_f32 v45, v19, v16
v_fmac_f32 v53, v19, v17
v_lshlrev_b32 v18, 16, v111
v_and_b32 v19, 0xffff0000, v111
v_fmac_f32 v46, v18, v16
v_fmac_f32 v54, v18, v17
v_fmac_f32 v47, v19, v16
v_fmac_f32 v55, v19, v17
ds_read_b64 v[16:17], v12 offset:384
s_waitcnt vmcnt(3) lgkmcnt(0)
v_lshlrev_b32 v18, 16, v112
v_and_b32 v19, 0xffff0000, v112
v_fmac_f32 v40, v18, v16
v_fmac_f32 v48, v18, v17
v_fmac_f32 v41, v19, v16
v_fmac_f32 v49, v19, v17
v_lshlrev_b32 v18, 16, v113
v_and_b32 v19, 0xffff0000, v113
v_fmac_f32 v42, v18, v16
v_fmac_f32 v50, v18, v17
v_fmac_f32 v43, v19, v16
v_fmac_f32 v51, v19, v17
v_lshlrev_b32 v18, 16, v114
v_and_b32 v19, 0xffff0000, v114
v_fmac_f32 v44, v18, v16
v_fmac_f32 v52, v18, v17
v_fmac_f32 v45, v19, v16
v_fmac_f32 v53, v19, v17
v_lshlrev_b32 v18, 16, v115
v_and_b32 v19, 0xffff0000, v115
v_fmac_f32 v46, v18, v16
v_fmac_f32 v54, v18, v17
v_fmac_f32 v47, v19, v16
v_fmac_f32 v55, v19, v17
ds_read_b64 v[16:17], v12 offset:416
s_waitcnt vmcnt(2) lgkmcnt(0)
v_lshlrev_b32 v18, 16, v116
v_and_b32 v19, 0xffff0000, v116
v_fmac_f32 v40, v18, v16
v_fmac_f32 v48, v18, v17
v_fmac_f32 v41, v19, v16
v_fmac_f32 v49, v19, v17
v_lshlrev_b32 v18, 16, v117
v_and_b32 v19, 0xffff0000, v117
v_fmac_f32 v42, v18, v16
v_fmac_f32 v50, v18, v17
v_fmac_f32 v43, v19, v16
v_fmac_f32 v51, v19, v17
v_lshlrev_b32 v18, 16, v118
v_and_b32 v19, 0xffff0000, v118
v_fmac_f32 v44, v18, v16
v_fmac_f32 v52, v18, v17
v_fmac_f32 v45, v19, v16
v_fmac_f32 v53, v19, v17
v_lshlrev_b32 v18, 16, v119
v_and_b32 v19, 0xffff0000, v119
v_fmac_f32 v46, v18, v16
v_fmac_f32 v54, v18, v17
v_fmac_f32 v47, v19, v16
v_fmac_f32 v55, v19, v17
ds_read_b64 v[16:17], v12 offset:448
s_waitcnt vmcnt(1) lgkmcnt(0)
v_lshlrev_b32 v18, 16, v120
v_and_b32 v19, 0xffff0000, v120
v_fmac_f32 v40, v18, v16
v_fmac_f32 v48, v18, v17
v_fmac_f32 v41, v19, v16
v_fmac_f32 v49, v19, v17
v_lshlrev_b32 v18, 16, v121
v_and_b32 v19, 0xffff0000, v121
v_fmac_f32 v42, v18, v16
v_fmac_f32 v50, v18, v17
v_fmac_f32 v43, v19, v16
v_fmac_f32 v51, v19, v17
v_lshlrev_b32 v18, 16, v122
v_and_b32 v19, 0xffff0000, v122
v_fmac_f32 v44, v18, v16
v_fmac_f32 v52, v18, v17
v_fmac_f32 v45, v19, v16
v_fmac_f32 v53, v19, v17
v_lshlrev_b32 v18, 16, v123
v_and_b32 v19, 0xffff0000, v123
v_fmac_f32 v46, v18, v16
v_fmac_f32 v54, v18, v17
v_fmac_f32 v47, v19, v16
v_fmac_f32 v55, v19, v17
ds_read_b64 v[16:17], v12 offset:480
s_waitcnt vmcnt(0) lgkmcnt(0)
v_lshlrev_b32 v18, 16, v124
v_and_b32 v19, 0xffff0000, v124
v_fmac_f32 v40, v18, v16
v_fmac_f32 v48, v18, v17
v_fmac_f32 v41, v19, v16
v_fmac_f32 v49, v19, v17
v_lshlrev_b32 v18, 16, v125
v_and_b32 v19, 0xffff0000, v125
v_fmac_f32 v42, v18, v16
v_fmac_f32 v50, v18, v17
v_fmac_f32 v43, v19, v16
v_fmac_f32 v51, v19, v17
v_lshlrev_b32 v18, 16, v126
v_and_b32 v19, 0xffff0000, v126
v_fmac_f32 v44, v18, v16
v_fmac_f32 v52, v18, v17
v_fmac_f32 v45, v19, v16
v_fmac_f32 v53, v19, v17
v_lshlrev_b32 v18, 16, v127
v_and_b32 v19, 0xffff0000, v127
v_fmac_f32 v46, v18, v16
v_fmac_f32 v54, v18, v17
v_fmac_f32 v47, v19, v16
v_fmac_f32 v55, v19, v17
v_mul_u32_u24 v12, 3584, v4
v_lshl_add_u32 v12, v3, 5, v12
v_add_u32 v12, 1024, v12
ds_write_b128 v12, v[40:43]
ds_write_b128 v12, v[44:47] offset:16
ds_write_b128 v12, v[48:51] offset:1792
ds_write_b128 v12, v[52:55] offset:1808
s_mov_b64 exec, s[12:13]
s_waitcnt lgkmcnt(0)
s_barrier
s_mul_i32 s6, s2, 3584
s_add_u32 s6, s6, 16777216
v_add_u32 v12, 0, v0
v_lshlrev_b32 v12, 2, v12
ds_read_b32 v20, v12 offset:1024
ds_read_b32 v21, v12 offset:4608
ds_read_b32 v22, v12 offset:8192
ds_read_b32 v23, v12 offset:11776
s_waitcnt lgkmcnt(0)
v_add_f32 v20, v20, v21
v_add_f32 v20, v20, v22
v_add_f32 v20, v20, v23
v_add_u32 v12, s6, v12
v_cmp_gt_u32 vcc, 256, v0
s_and_saveexec_b64 s[12:13], vcc
global_store_dword v12, v20, s[40:41]
s_mov_b64 exec, s[12:13]
v_add_u32 v12, 256, v0
v_lshlrev_b32 v12, 2, v12
ds_read_b32 v20, v12 offset:1024
ds_read_b32 v21, v12 offset:4608
ds_read_b32 v22, v12 offset:8192
ds_read_b32 v23, v12 offset:11776
s_waitcnt lgkmcnt(0)
v_add_f32 v20, v20, v21
v_add_f32 v20, v20, v22
v_add_f32 v20, v20, v23
v_add_u32 v12, s6, v12
v_cmp_gt_u32 vcc, 256, v0
s_and_saveexec_b64 s[12:13], vcc
global_store_dword v12, v20, s[40:41]
s_mov_b64 exec, s[12:13]
v_add_u32 v12, 512, v0
v_lshlrev_b32 v12, 2, v12
ds_read_b32 v20, v12 offset:1024
ds_read_b32 v21, v12 offset:4608
ds_read_b32 v22, v12 offset:8192
ds_read_b32 v23, v12 offset:11776
s_waitcnt lgkmcnt(0)
v_add_f32 v20, v20, v21
v_add_f32 v20, v20, v22
v_add_f32 v20, v20, v23
v_add_u32 v12, s6, v12
v_cmp_gt_u32 vcc, 256, v0
s_and_saveexec_b64 s[12:13], vcc
global_store_dword v12, v20, s[40:41]
s_mov_b64 exec, s[12:13]
v_add_u32 v12, 768, v0
v_lshlrev_b32 v12, 2, v12
ds_read_b32 v20, v12 offset:1024
ds_read_b32 v21, v12 offset:4608
ds_read_b32 v22, v12 offset:8192
ds_read_b32 v23, v12 offset:11776
s_waitcnt lgkmcnt(0)
v_add_f32 v20, v20, v21
v_add_f32 v20, v20, v22
v_add_f32 v20, v20, v23
v_add_u32 v12, s6, v12
v_cmp_gt_u32 vcc, 128, v0
s_and_saveexec_b64 s[12:13], vcc
global_store_dword v12, v20, s[40:41]
s_mov_b64 exec, s[12:13]
kb_kernel_end:
s_endpgm
.section .rodata,"a"
.p2align 6
.amdhsa_kernel kb_kernel
  .amdhsa_next_free_vgpr 192
  .amdhsa_next_free_sgpr 96
  .amdhsa_accum_offset 192
  .amdhsa_group_segment_fixed_size 0
  .amdhsa_kernarg_size 112
  .amdhsa_user_sgpr_count 2
  .amdhsa_user_sgpr_kernarg_segment_ptr 1
  .amdhsa_system_sgpr_workgroup_id_x 1
.end_amdhsa_kernel
.text
.globl kc_kernel
.p2align 8
.type kc_kernel,@function
kc_kernel:
s_cmp_ge_u32 s2, 256
s_cbranch_scc1 kc_kernel_end
s_load_dwordx16 s[16:31], s[0:1], 0
s_load_dwordx8 s[32:39], s[0:1], 64
s_load_dwordx2 s[40:41], s[0:1], 104
s_waitcnt lgkmcnt(0)
v_and_b32 v1, 63, v0
v_lshrrev_b32 v2, 6, v0
s_nop 0
v_readfirstlane_b32 s3, v2
s_and_b32 s4, s2, 7
s_lshl_b32 s4, s4, 1
s_bfe_u32 s5, s2, 0x10003
s_add_u32 s4, s4, s5
s_lshr_b32 s5, s2, 4
v_and_b32 v3, 7, v0
v_lshrrev_b32 v4, 3, v0
v_lshlrev_b32 v5, 15, v4
v_lshl_add_u32 v5, v3, 4, v5
s_lshl_b32 s6, s4, 11
s_lshl_b32 s7, s5, 7
s_add_u32 s6, s6, s7
s_add_u32 s6, s6, 1048576
v_add_u32 v5, s6, v5
global_load_dwordx4 v[64:67], v5, s[40:41]
v_add_u32 v5, 2097152, v5
global_load_dwordx4 v[68:71], v5, s[40:41]
v_add_u32 v5, 2097152, v5
global_load_dwordx4 v[72:75], v5, s[40:41]
v_add_u32 v5, 2097152, v5
global_load_dwordx4 v[76:79], v5, s[40:41]
v_and_b32 v6, 31, v0
v_lshrrev_b32 v7, 5, v0
s_lshl_b32 s8, s5, 6
v_add_u32 v8, s8, v7
v_lshlrev_b32 v8, 13, v8
v_lshl_add_u32 v8, v6, 4, v8
s_lshl_b32 s9, s4, 9
v_add_u32 v8, s9, v8
global_load_dwordx4 v[80:83], v8, s[24:25]
v_add_u32 v8, 131072, v8
global_load_dwordx4 v[84:87], v8, s[24:25]
v_add_u32 v8, 131072, v8
global_load_dwordx4 v[88:91], v8, s[24:25]
v_add_u32 v8, 131072, v8
global_load_dwordx4 v[92:95], v8, s[24:25]
v_mul_u32_u24 v10, 1171, v0
v_lshrrev_b32 v10, 16, v10
v_mul_u32_u24 v9, 56, v10
v_sub_u32 v9, v0, v9
v_min_u32 v10, 7, v10
s_lshl_b32 s9, s4, 8
v_add_u32 v11, s9, v10
v_mul_u32_u24 v11, 896, v11
v_lshl_add_u32 v11, v9, 4, v11
global_load_dwordx4 v[128:131], v11, s[26:27]
v_add_u32 v11, 7168, v11
global_load_dwordx4 v[132:135], v11, s[26:27]
v_add_u32 v11, 7168, v11
global_load_dwordx4 v[136:139], v11, s[26:27]
v_add_u32 v11, 7168, v11
global_load_dwordx4 v[140:143], v11, s[26:27]
v_add_u32 v11, 7168, v11
global_load_dwordx4 v[144:147], v11, s[26:27]
v_add_u32 v11, 7168, v11
global_load_dwordx4 v[148:151], v11, s[26:27]
v_add_u32 v11, 7168, v11
global_load_dwordx4 v[152:155], v11, s[26:27]
v_add_u32 v11, 7168, v11
global_load_dwordx4 v[156:159], v11, s[26:27]
v_add_u32 v11, 7168, v11
global_load_dwordx4 v[160:163], v11, s[26:27]
v_add_u32 v11, 7168, v11
global_load_dwordx4 v[164:167], v11, s[26:27]
v_add_u32 v11, 7168, v11
global_load_dwordx4 v[168:171], v11, s[26:27]
v_add_u32 v11, 7168, v11
global_load_dwordx4 v[172:175], v11, s[26:27]
v_add_u32 v11, 7168, v11
global_load_dwordx4 v[176:179], v11, s[26:27]
v_add_u32 v11, 7168, v11
global_load_dwordx4 v[180:183], v11, s[26:27]
v_add_u32 v11, 7168, v11
global_load_dwordx4 v[184:187], v11, s[26:27]
v_add_u32 v11, 7168, v11
global_load_dwordx4 v[188:191], v11, s[26:27]
v_add_u32 v11, 7168, v11
global_load_dwordx4 v[192:195], v11, s[26:27]
v_add_u32 v11, 7168, v11
global_load_dwordx4 v[196:199], v11, s[26:27]
v_add_u32 v11, 7168, v11
global_load_dwordx4 v[200:203], v11, s[26:27]
v_add_u32 v11, 7168, v11
global_load_dwordx4 v[204:207], v11, s[26:27]
v_add_u32 v11, 7168, v11
global_load_dwordx4 v[208:211], v11, s[26:27]
v_add_u32 v11, 7168, v11
global_load_dwordx4 v[212:215], v11, s[26:27]
v_add_u32 v11, 7168, v11
global_load_dwordx4 v[216:219], v11, s[26:27]
v_add_u32 v11, 7168, v11
global_load_dwordx4 v[220:223], v11, s[26:27]
v_add_u32 v11, 7168, v11
global_load_dwordx4 v[224:227], v11, s[26:27]
v_add_u32 v11, 7168, v11
global_load_dwordx4 v[228:231], v11, s[26:27]
v_add_u32 v11, 7168, v11
global_load_dwordx4 v[232:235], v11, s[26:27]
v_add_u32 v11, 7168, v11
global_load_dwordx4 v[236:239], v11, s[26:27]
v_add_u32 v11, 7168, v11
global_load_dwordx4 v[240:243], v11, s[26:27]
v_add_u32 v11, 7168, v11
global_load_dwordx4 v[244:247], v11, s[26:27]
v_add_u32 v11, 7168, v11
global_load_dwordx4 v[248:251], v11, s[26:27]
v_add_u32 v11, 7168, v11
global_load_dwordx4 v[252:255], v11, s[26:27]
s_cmp_ge_u32 s3, 2
s_cbranch_scc1 kc_st
s_lshl_b32 s10, s3, 13
s_lshl_b32 s11, s4, 2
s_add_u32 s10, s10, s11
v_lshl_add_u32 v12, v1, 6, s10
v_add_u32 v13, 131072, v12
v_add_u32 v12, 147456, v12
global_load_dword v14, v13, s[40:41]
global_load_dword v16, v12, s[40:41]
v_add_u32 v13, 4096, v13
v_add_u32 v12, 4096, v12
global_load_dword v15, v13, s[40:41]
global_load_dword v17, v12, s[40:41]
s_waitcnt vmcnt(0)
v_max_f32 v18, v14, v15
v_xor_b32 v19, 1, v1
v_lshlrev_b32 v19, 2, v19
ds_bpermute_b32 v19, v19, v18
s_waitcnt lgkmcnt(0)
v_max_f32 v18, v18, v19
v_xor_b32 v19, 2, v1
v_lshlrev_b32 v19, 2, v19
ds_bpermute_b32 v19, v19, v18
s_waitcnt lgkmcnt(0)
v_max_f32 v18, v18, v19
v_xor_b32 v19, 4, v1
v_lshlrev_b32 v19, 2, v19
ds_bpermute_b32 v19, v19, v18
s_waitcnt lgkmcnt(0)
v_max_f32 v18, v18, v19
v_xor_b32 v19, 8, v1
v_lshlrev_b32 v19, 2, v19
ds_bpermute_b32 v19, v19, v18
s_waitcnt lgkmcnt(0)
v_max_f32 v18, v18, v19
v_xor_b32 v19, 16, v1
v_lshlrev_b32 v19, 2, v19
ds_bpermute_b32 v19, v19, v18
s_waitcnt lgkmcnt(0)
v_max_f32 v18, v18, v19
v_xor_b32 v19, 32, v1
v_lshlrev_b32 v19, 2, v19
ds_bpermute_b32 v19, v19, v18
s_waitcnt lgkmcnt(0)
v_max_f32 v18, v18, v19
v_sub_f32 v14, v14, v18
v_sub_f32 v15, v15, v18
v_mul_f32 v14, 0x3db8aa3b, v14
v_mul_f32 v15, 0x3db8aa3b, v15
v_exp_f32 v14, v14
v_exp_f32 v15, v15
s_nop 0
v_mul_f32 v18, v14, v16
v_fmac_f32 v18, v15, v17
v_xor_b32 v19, 1, v1
v_lshlrev_b32 v19, 2, v19
ds_bpermute_b32 v19, v19, v18
s_waitcnt lgkmcnt(0)
v_add_f32 v18, v18, v19
v_xor_b32 v19, 2, v1
v_lshlrev_b32 v19, 2, v19
ds_bpermute_b32 v19, v19, v18
s_waitcnt lgkmcnt(0)
v_add_f32 v18, v18, v19
v_xor_b32 v19, 4, v1
v_lshlrev_b32 v19, 2, v19
ds_bpermute_b32 v19, v19, v18
s_waitcnt lgkmcnt(0)
v_add_f32 v18, v18, v19
v_xor_b32 v19, 8, v1
v_lshlrev_b32 v19, 2, v19
ds_bpermute_b32 v19, v19, v18
s_waitcnt lgkmcnt(0)
v_add_f32 v18, v18, v19
v_xor_b32 v19, 16, v1
v_lshlrev_b32 v19, 2, v19
ds_bpermute_b32 v19, v19, v18
s_waitcnt lgkmcnt(0)
v_add_f32 v18, v18, v19
v_xor_b32 v19, 32, v1
v_lshlrev_b32 v19, 2, v19
ds_bpermute_b32 v19, v19, v18
s_waitcnt lgkmcnt(0)
v_add_f32 v18, v18, v19
v_rcp_f32 v18, v18
s_nop 0
v_mul_f32 v14, v14, v18
v_mul_f32 v15, v15, v18
s_lshl_b32 s10, s3, 9
v_lshl_add_u32 v19, v1, 2, s10
ds_write_b32 v19, v14
ds_write_b32 v19, v15 offset:256
kc_st:
s_waitcnt lgkmcnt(0)
s_barrier
v_mov_b32 v40, 0
v_mov_b32 v41, 0
v_mov_b32 v42, 0
v_mov_b32 v43, 0
v_mov_b32 v44, 0
v_mov_b32 v45, 0
v_mov_b32 v46, 0
v_mov_b32 v47, 0
v_mov_b32 v48, 0
v_mov_b32 v49, 0
v_mov_b32 v50, 0
v_mov_b32 v51, 0
v_mov_b32 v52, 0
v_mov_b32 v53, 0
v_mov_b32 v54, 0
v_mov_b32 v55, 0
v_lshlrev_b32 v12, 2, v4
ds_read_b32 v16, v12 offset:0
s_waitcnt vmcnt(39) lgkmcnt(0)
v_lshlrev_b32 v18, 16, v64
v_and_b32 v19, 0xffff0000, v64
v_fmac_f32 v40, v18, v16
v_fmac_f32 v41, v19, v16
v_lshlrev_b32 v18, 16, v65
v_and_b32 v19, 0xffff0000, v65
v_fmac_f32 v42, v18, v16
v_fmac_f32 v43, v19, v16
v_lshlrev_b32 v18, 16, v66
v_and_b32 v19, 0xffff0000, v66
v_fmac_f32 v44, v18, v16
v_fmac_f32 v45, v19, v16
v_lshlrev_b32 v18, 16, v67
v_and_b32 v19, 0xffff0000, v67
v_fmac_f32 v46, v18, v16
v_fmac_f32 v47, v19, v16
ds_read_b32 v16, v12 offset:256
s_waitcnt vmcnt(38) lgkmcnt(0)
v_lshlrev_b32 v18, 16, v68
v_and_b32 v19, 0xffff0000, v68
v_fmac_f32 v40, v18, v16
v_fmac_f32 v41, v19, v16
v_lshlrev_b32 v18, 16, v69
v_and_b32 v19, 0xffff0000, v69
v_fmac_f32 v42, v18, v16
v_fmac_f32 v43, v19, v16
v_lshlrev_b32 v18, 16, v70
v_and_b32 v19, 0xffff0000, v70
v_fmac_f32 v44, v18, v16
v_fmac_f32 v45, v19, v16
v_lshlrev_b32 v18, 16, v71
v_and_b32 v19, 0xffff0000, v71
v_fmac_f32 v46, v18, v16
v_fmac_f32 v47, v19, v16
ds_read_b32 v16, v12 offset:512
s_waitcnt vmcnt(37) lgkmcnt(0)
v_lshlrev_b32 v18, 16, v72
v_and_b32 v19, 0xffff0000, v72
v_fmac_f32 v48, v18, v16
v_fmac_f32 v49, v19, v16
v_lshlrev_b32 v18, 16, v73
v_and_b32 v19, 0xffff0000, v73
v_fmac_f32 v50, v18, v16
v_fmac_f32 v51, v19, v16
v_lshlrev_b32 v18, 16, v74
v_and_b32 v19, 0xffff0000, v74
v_fmac_f32 v52, v18, v16
v_fmac_f32 v53, v19, v16
v_lshlrev_b32 v18, 16, v75
v_and_b32 v19, 0xffff0000, v75
v_fmac_f32 v54, v18, v16
v_fmac_f32 v55, v19, v16
ds_read_b32 v16, v12 offset:768
s_waitcnt vmcnt(36) lgkmcnt(0)
v_lshlrev_b32 v18, 16, v76
v_and_b32 v19, 0xffff0000, v76
v_fmac_f32 v48, v18, v16
v_fmac_f32 v49, v19, v16
v_lshlrev_b32 v18, 16, v77
v_and_b32 v19, 0xffff0000, v77
v_fmac_f32 v50, v18, v16
v_fmac_f32 v51, v19, v16
v_lshlrev_b32 v18, 16, v78
v_and_b32 v19, 0xffff0000, v78
v_fmac_f32 v52, v18, v16
v_fmac_f32 v53, v19, v16
v_lshlrev_b32 v18, 16, v79
v_and_b32 v19, 0xffff0000, v79
v_fmac_f32 v54, v18, v16
v_fmac_f32 v55, v19, v16
v_lshlrev_b32 v12, 9, v4
v_lshl_add_u32 v12, v3, 5, v12
v_add_u32 v12, 4096, v12
ds_write_b128 v12, v[40:43]
ds_write_b128 v12, v[44:47] offset:16
ds_write_b128 v12, v[48:51] offset:256
ds_write_b128 v12, v[52:55] offset:272
s_waitcnt lgkmcnt(0)
s_barrier
s_cmp_ge_u32 s3, 2
s_cbranch_scc1 kc_l2
v_lshlrev_b32 v12, 2, v0
v_mov_b32 v13, 0
ds_read_b32 v20, v12 offset:4096
ds_read_b32 v21, v12 offset:4608
ds_read_b32 v22, v12 offset:5120
ds_read_b32 v23, v12 offset:5632
ds_read_b32 v24, v12 offset:6144
ds_read_b32 v25, v12 offset:6656
ds_read_b32 v26, v12 offset:7168
ds_read_b32 v27, v12 offset:7680
ds_read_b32 v28, v12 offset:8192
ds_read_b32 v29, v12 offset:8704
ds_read_b32 v30, v12 offset:9216
ds_read_b32 v31, v12 offset:9728
ds_read_b32 v32, v12 offset:10240
ds_read_b32 v33, v12 offset:10752
ds_read_b32 v34, v12 offset:11264
ds_read_b32 v35, v12 offset:11776
s_waitcnt lgkmcnt(0)
v_add_f32 v13, v13, v20
v_add_f32 v13, v13, v21
v_add_f32 v13, v13, v22
v_add_f32 v13, v13, v23
v_add_f32 v13, v13, v24
v_add_f32 v13, v13, v25
v_add_f32 v13, v13, v26
v_add_f32 v13, v13, v27
v_add_f32 v13, v13, v28
v_add_f32 v13, v13, v29
v_add_f32 v13, v13, v30
v_add_f32 v13, v13, v31
v_add_f32 v13, v13, v32
v_add_f32 v13, v13, v33
v_add_f32 v13, v13, v34
v_add_f32 v13, v13, v35
ds_read_b32 v20, v12 offset:12288
ds_read_b32 v21, v12 offset:12800
ds_read_b32 v22, v12 offset:13312
ds_read_b32 v23, v12 offset:13824
ds_read_b32 v24, v12 offset:14336
ds_read_b32 v25, v12 offset:14848
ds_read_b32 v26, v12 offset:15360
ds_read_b32 v27, v12 offset:15872
ds_read_b32 v28, v12 offset:16384
ds_read_b32 v29, v12 offset:16896
ds_read_b32 v30, v12 offset:17408
ds_read_b32 v31, v12 offset:17920
ds_read_b32 v32, v12 offset:18432
ds_read_b32 v33, v12 offset:18944
ds_read_b32 v34, v12 offset:19456
ds_read_b32 v35, v12 offset:19968
s_waitcnt lgkmcnt(0)
v_add_f32 v13, v13, v20
v_add_f32 v13, v13, v21
v_add_f32 v13, v13, v22
v_add_f32 v13, v13, v23
v_add_f32 v13, v13, v24
v_add_f32 v13, v13, v25
v_add_f32 v13, v13, v26
v_add_f32 v13, v13, v27
v_add_f32 v13, v13, v28
v_add_f32 v13, v13, v29
v_add_f32 v13, v13, v30
v_add_f32 v13, v13, v31
v_add_f32 v13, v13, v32
v_add_f32 v13, v13, v33
v_add_f32 v13, v13, v34
v_add_f32 v13, v13, v35
ds_read_b32 v20, v12 offset:20480
ds_read_b32 v21, v12 offset:20992
ds_read_b32 v22, v12 offset:21504
ds_read_b32 v23, v12 offset:22016
ds_read_b32 v24, v12 offset:22528
ds_read_b32 v25, v12 offset:23040
ds_read_b32 v26, v12 offset:23552
ds_read_b32 v27, v12 offset:24064
ds_read_b32 v28, v12 offset:24576
ds_read_b32 v29, v12 offset:25088
ds_read_b32 v30, v12 offset:25600
ds_read_b32 v31, v12 offset:26112
ds_read_b32 v32, v12 offset:26624
ds_read_b32 v33, v12 offset:27136
ds_read_b32 v34, v12 offset:27648
ds_read_b32 v35, v12 offset:28160
s_waitcnt lgkmcnt(0)
v_add_f32 v13, v13, v20
v_add_f32 v13, v13, v21
v_add_f32 v13, v13, v22
v_add_f32 v13, v13, v23
v_add_f32 v13, v13, v24
v_add_f32 v13, v13, v25
v_add_f32 v13, v13, v26
v_add_f32 v13, v13, v27
v_add_f32 v13, v13, v28
v_add_f32 v13, v13, v29
v_add_f32 v13, v13, v30
v_add_f32 v13, v13, v31
v_add_f32 v13, v13, v32
v_add_f32 v13, v13, v33
v_add_f32 v13, v13, v34
v_add_f32 v13, v13, v35
ds_read_b32 v20, v12 offset:28672
ds_read_b32 v21, v12 offset:29184
ds_read_b32 v22, v12 offset:29696
ds_read_b32 v23, v12 offset:30208
ds_read_b32 v24, v12 offset:30720
ds_read_b32 v25, v12 offset:31232
ds_read_b32 v26, v12 offset:31744
ds_read_b32 v27, v12 offset:32256
ds_read_b32 v28, v12 offset:32768
ds_read_b32 v29, v12 offset:33280
ds_read_b32 v30, v12 offset:33792
ds_read_b32 v31, v12 offset:34304
ds_read_b32 v32, v12 offset:34816
ds_read_b32 v33, v12 offset:35328
ds_read_b32 v34, v12 offset:35840
ds_read_b32 v35, v12 offset:36352
s_waitcnt lgkmcnt(0)
v_add_f32 v13, v13, v20
v_add_f32 v13, v13, v21
v_add_f32 v13, v13, v22
v_add_f32 v13, v13, v23
v_add_f32 v13, v13, v24
v_add_f32 v13, v13, v25
v_add_f32 v13, v13, v26
v_add_f32 v13, v13, v27
v_add_f32 v13, v13, v28
v_add_f32 v13, v13, v29
v_add_f32 v13, v13, v30
v_add_f32 v13, v13, v31
v_add_f32 v13, v13, v32
v_add_f32 v13, v13, v33
v_add_f32 v13, v13, v34
v_add_f32 v13, v13, v35
v_and_b32 v12, 63, v0
v_lshlrev_b32 v12, 3, v12
v_lshl_add_u32 v12, v2, 2, v12
ds_write_b32 v12, v13 offset:1024
kc_l2:
s_waitcnt lgkmcnt(0)
s_barrier
v_mov_b32 v40, 0
v_mov_b32 v41, 0
v_mov_b32 v42, 0
v_mov_b32 v43, 0
v_mov_b32 v44, 0
v_mov_b32 v45, 0
v_mov_b32 v46, 0
v_mov_b32 v47, 0
v_mov_b32 v48, 0
v_mov_b32 v49, 0
v_mov_b32 v50, 0
v_mov_b32 v51, 0
v_mov_b32 v52, 0
v_mov_b32 v53, 0
v_mov_b32 v54, 0
v_mov_b32 v55, 0
v_lshlrev_b32 v12, 3, v7
v_add_u32 v12, 1024, v12
ds_read_b64 v[16:17], v12 offset:0
s_waitcnt vmcnt(32) lgkmcnt(0)
v_lshlrev_b32 v18, 16, v80
v_and_b32 v19, 0xffff0000, v80
v_fmac_f32 v40, v18, v16
v_fmac_f32 v48, v18, v17
v_fmac_f32 v41, v19, v16
v_fmac_f32 v49, v19, v17
v_lshlrev_b32 v18, 16, v81
v_and_b32 v19, 0xffff0000, v81
v_fmac_f32 v42, v18, v16
v_fmac_f32 v50, v18, v17
v_fmac_f32 v43, v19, v16
v_fmac_f32 v51, v19, v17
v_lshlrev_b32 v18, 16, v82
v_and_b32 v19, 0xffff0000, v82
v_fmac_f32 v44, v18, v16
v_fmac_f32 v52, v18, v17
v_fmac_f32 v45, v19, v16
v_fmac_f32 v53, v19, v17
v_lshlrev_b32 v18, 16, v83
v_and_b32 v19, 0xffff0000, v83
v_fmac_f32 v46, v18, v16
v_fmac_f32 v54, v18, v17
v_fmac_f32 v47, v19, v16
v_fmac_f32 v55, v19, v17
ds_read_b64 v[16:17], v12 offset:128
s_waitcnt vmcnt(32) lgkmcnt(0)
v_lshlrev_b32 v18, 16, v84
v_and_b32 v19, 0xffff0000, v84
v_fmac_f32 v40, v18, v16
v_fmac_f32 v48, v18, v17
v_fmac_f32 v41, v19, v16
v_fmac_f32 v49, v19, v17
v_lshlrev_b32 v18, 16, v85
v_and_b32 v19, 0xffff0000, v85
v_fmac_f32 v42, v18, v16
v_fmac_f32 v50, v18, v17
v_fmac_f32 v43, v19, v16
v_fmac_f32 v51, v19, v17
v_lshlrev_b32 v18, 16, v86
v_and_b32 v19, 0xffff0000, v86
v_fmac_f32 v44, v18, v16
v_fmac_f32 v52, v18, v17
v_fmac_f32 v45, v19, v16
v_fmac_f32 v53, v19, v17
v_lshlrev_b32 v18, 16, v87
v_and_b32 v19, 0xffff0000, v87
v_fmac_f32 v46, v18, v16
v_fmac_f32 v54, v18, v17
v_fmac_f32 v47, v19, v16
v_fmac_f32 v55, v19, v17
ds_read_b64 v[16:17], v12 offset:256
s_waitcnt vmcnt(32) lgkmcnt(0)
v_lshlrev_b32 v18, 16, v88
v_and_b32 v19, 0xffff0000, v88
v_fmac_f32 v40, v18, v16
v_fmac_f32 v48, v18, v17
v_fmac_f32 v41, v19, v16
v_fmac_f32 v49, v19, v17
v_lshlrev_b32 v18, 16, v89
v_and_b32 v19, 0xffff0000, v89
v_fmac_f32 v42, v18, v16
v_fmac_f32 v50, v18, v17
v_fmac_f32 v43, v19, v16
v_fmac_f32 v51, v19, v17
v_lshlrev_b32 v18, 16, v90
v_and_b32 v19, 0xffff0000, v90
v_fmac_f32 v44, v18, v16
v_fmac_f32 v52, v18, v17
v_fmac_f32 v45, v19, v16
v_fmac_f32 v53, v19, v17
v_lshlrev_b32 v18, 16, v91
v_and_b32 v19, 0xffff0000, v91
v_fmac_f32 v46, v18, v16
v_fmac_f32 v54, v18, v17
v_fmac_f32 v47, v19, v16
v_fmac_f32 v55, v19, v17
ds_read_b64 v[16:17], v12 offset:384
s_waitcnt vmcnt(32) lgkmcnt(0)
v_lshlrev_b32 v18, 16, v92
v_and_b32 v19, 0xffff0000, v92
v_fmac_f32 v40, v18, v16
v_fmac_f32 v48, v18, v17
v_fmac_f32 v41, v19, v16
v_fmac_f32 v49, v19, v17
v_lshlrev_b32 v18, 16, v93
v_and_b32 v19, 0xffff0000, v93
v_fmac_f32 v42, v18, v16
v_fmac_f32 v50, v18, v17
v_fmac_f32 v43, v19, v16
v_fmac_f32 v51, v19, v17
v_lshlrev_b32 v18, 16, v94
v_and_b32 v19, 0xffff0000, v94
v_fmac_f32 v44, v18, v16
v_fmac_f32 v52, v18, v17
v_fmac_f32 v45, v19, v16
v_fmac_f32 v53, v19, v17
v_lshlrev_b32 v18, 16, v95
v_and_b32 v19, 0xffff0000, v95
v_fmac_f32 v46, v18, v16
v_fmac_f32 v54, v18, v17
v_fmac_f32 v47, v19, v16
v_fmac_f32 v55, v19, v17
v_lshlrev_b32 v12, 11, v7
v_lshl_add_u32 v12, v6, 5, v12
v_add_u32 v12, 4096, v12
ds_write_b128 v12, v[40:43]
ds_write_b128 v12, v[44:47] offset:16
ds_write_b128 v12, v[48:51] offset:1024
ds_write_b128 v12, v[52:55] offset:1040
s_waitcnt lgkmcnt(0)
s_barrier
v_lshlrev_b32 v12, 2, v0
v_mov_b32 v13, 0
ds_read_b32 v20, v12 offset:4096
ds_read_b32 v21, v12 offset:6144
ds_read_b32 v22, v12 offset:8192
ds_read_b32 v23, v12 offset:10240
ds_read_b32 v24, v12 offset:12288
ds_read_b32 v25, v12 offset:14336
ds_read_b32 v26, v12 offset:16384
ds_read_b32 v27, v12 offset:18432
ds_read_b32 v28, v12 offset:20480
ds_read_b32 v29, v12 offset:22528
ds_read_b32 v30, v12 offset:24576
ds_read_b32 v31, v12 offset:26624
ds_read_b32 v32, v12 offset:28672
ds_read_b32 v33, v12 offset:30720
ds_read_b32 v34, v12 offset:32768
ds_read_b32 v35, v12 offset:34816
s_waitcnt lgkmcnt(0)
v_add_f32 v13, v13, v20
v_add_f32 v13, v13, v21
v_add_f32 v13, v13, v22
v_add_f32 v13, v13, v23
v_add_f32 v13, v13, v24
v_add_f32 v13, v13, v25
v_add_f32 v13, v13, v26
v_add_f32 v13, v13, v27
v_add_f32 v13, v13, v28
v_add_f32 v13, v13, v29
v_add_f32 v13, v13, v30
v_add_f32 v13, v13, v31
v_add_f32 v13, v13, v32
v_add_f32 v13, v13, v33
v_add_f32 v13, v13, v34
v_add_f32 v13, v13, v35
s_barrier
v_and_b32 v12, 255, v0
v_lshlrev_b32 v12, 3, v12
v_lshrrev_b32 v14, 8, v0
v_lshl_add_u32 v12, v14, 2, v12
ds_write_b32 v12, v13 offset:2048
s_waitcnt lgkmcnt(0)
s_barrier
v_mov_b32 v40, 0
v_mov_b32 v41, 0
v_mov_b32 v42, 0
v_mov_b32 v43, 0
v_mov_b32 v44, 0
v_mov_b32 v45, 0
v_mov_b32 v46, 0
v_mov_b32 v47, 0
v_mov_b32 v48, 0
v_mov_b32 v49, 0
v_mov_b32 v50, 0
v_mov_b32 v51, 0
v_mov_b32 v52, 0
v_mov_b32 v53, 0
v_mov_b32 v54, 0
v_mov_b32 v55, 0
v_lshlrev_b32 v12, 3, v10
v_add_u32 v12, 2048, v12
ds_read_b64 v[16:17], v12 offset:0
s_waitcnt vmcnt(31) lgkmcnt(0)
v_lshlrev_b32 v18, 16, v128
v_and_b32 v19, 0xffff0000, v128
v_fmac_f32 v40, v18, v16
v_fmac_f32 v48, v18, v17
v_fmac_f32 v41, v19, v16
v_fmac_f32 v49, v19, v17
v_lshlrev_b32 v18, 16, v129
v_and_b32 v19, 0xffff0000, v129
v_fmac_f32 v42, v18, v16
v_fmac_f32 v50, v18, v17
v_fmac_f32 v43, v19, v16
v_fmac_f32 v51, v19, v17
v_lshlrev_b32 v18, 16, v130
v_and_b32 v19, 0xffff0000, v130
v_fmac_f32 v44, v18, v16
v_fmac_f32 v52, v18, v17
v_fmac_f32 v45, v19, v16
v_fmac_f32 v53, v19, v17
v_lshlrev_b32 v18, 16, v131
v_and_b32 v19, 0xffff0000, v131
v_fmac_f32 v46, v18, v16
v_fmac_f32 v54, v18, v17
v_fmac_f32 v47, v19, v16
v_fmac_f32 v55, v19, v17
ds_read_b64 v[16:17], v12 offset:64
s_waitcnt vmcnt(30) lgkmcnt(0)
v_lshlrev_b32 v18, 16, v132
v_and_b32 v19, 0xffff0000, v132
v_fmac_f32 v40, v18, v16
v_fmac_f32 v48, v18, v17
v_fmac_f32 v41, v19, v16
v_fmac_f32 v49, v19, v17
v_lshlrev_b32 v18, 16, v133
v_and_b32 v19, 0xffff0000, v133
v_fmac_f32 v42, v18, v16
v_fmac_f32 v50, v18, v17
v_fmac_f32 v43, v19, v16
v_fmac_f32 v51, v19, v17
v_lshlrev_b32 v18, 16, v134
v_and_b32 v19, 0xffff0000, v134
v_fmac_f32 v44, v18, v16
v_fmac_f32 v52, v18, v17
v_fmac_f32 v45, v19, v16
v_fmac_f32 v53, v19, v17
v_lshlrev_b32 v18, 16, v135
v_and_b32 v19, 0xffff0000, v135
v_fmac_f32 v46, v18, v16
v_fmac_f32 v54, v18, v17
v_fmac_f32 v47, v19, v16
v_fmac_f32 v55, v19, v17
ds_read_b64 v[16:17], v12 offset:128
s_waitcnt vmcnt(29) lgkmcnt(0)
v_lshlrev_b32 v18, 16, v136
v_and_b32 v19, 0xffff0000, v136
v_fmac_f32 v40, v18, v16
v_fmac_f32 v48, v18, v17
v_fmac_f32 v41, v19, v16
v_fmac_f32 v49, v19, v17
v_lshlrev_b32 v18, 16, v137
v_and_b32 v19, 0xffff0000, v137
v_fmac_f32 v42, v18, v16
v_fmac_f32 v50, v18, v17
v_fmac_f32 v43, v19, v16
v_fmac_f32 v51, v19, v17
v_lshlrev_b32 v18, 16, v138
v_and_b32 v19, 0xffff0000, v138
v_fmac_f32 v44, v18, v16
v_fmac_f32 v52, v18, v17
v_fmac_f32 v45, v19, v16
v_fmac_f32 v53, v19, v17
v_lshlrev_b32 v18, 16, v139
v_and_b32 v19, 0xffff0000, v139
v_fmac_f32 v46, v18, v16
v_fmac_f32 v54, v18, v17
v_fmac_f32 v47, v19, v16
v_fmac_f32 v55, v19, v17
ds_read_b64 v[16:17], v12 offset:192
s_waitcnt vmcnt(28) lgkmcnt(0)
v_lshlrev_b32 v18, 16, v140
v_and_b32 v19, 0xffff0000, v140
v_fmac_f32 v40, v18, v16
v_fmac_f32 v48, v18, v17
v_fmac_f32 v41, v19, v16
v_fmac_f32 v49, v19, v17
v_lshlrev_b32 v18, 16, v141
v_and_b32 v19, 0xffff0000, v141
v_fmac_f32 v42, v18, v16
v_fmac_f32 v50, v18, v17
v_fmac_f32 v43, v19, v16
v_fmac_f32 v51, v19, v17
v_lshlrev_b32 v18, 16, v142
v_and_b32 v19, 0xffff0000, v142
v_fmac_f32 v44, v18, v16
v_fmac_f32 v52, v18, v17
v_fmac_f32 v45, v19, v16
v_fmac_f32 v53, v19, v17
v_lshlrev_b32 v18, 16, v143
v_and_b32 v19, 0xffff0000, v143
v_fmac_f32 v46, v18, v16
v_fmac_f32 v54, v18, v17
v_fmac_f32 v47, v19, v16
v_fmac_f32 v55, v19, v17
ds_read_b64 v[16:17], v12 offset:256
s_waitcnt vmcnt(27) lgkmcnt(0)
v_lshlrev_b32 v18, 16, v144
v_and_b32 v19, 0xffff0000, v144
v_fmac_f32 v40, v18, v16
v_fmac_f32 v48, v18, v17
v_fmac_f32 v41, v19, v16
v_fmac_f32 v49, v19, v17
v_lshlrev_b32 v18, 16, v145
v_and_b32 v19, 0xffff0000, v145
v_fmac_f32 v42, v18, v16
v_fmac_f32 v50, v18, v17
v_fmac_f32 v43, v19, v16
v_fmac_f32 v51, v19, v17
v_lshlrev_b32 v18, 16, v146
v_and_b32 v19, 0xffff0000, v146
v_fmac_f32 v44, v18, v16
v_fmac_f32 v52, v18, v17
v_fmac_f32 v45, v19, v16
v_fmac_f32 v53, v19, v17
v_lshlrev_b32 v18, 16, v147
v_and_b32 v19, 0xffff0000, v147
v_fmac_f32 v46, v18, v16
v_fmac_f32 v54, v18, v17
v_fmac_f32 v47, v19, v16
v_fmac_f32 v55, v19, v17
ds_read_b64 v[16:17], v12 offset:320
s_waitcnt vmcnt(26) lgkmcnt(0)
v_lshlrev_b32 v18, 16, v148
v_and_b32 v19, 0xffff0000, v148
v_fmac_f32 v40, v18, v16
v_fmac_f32 v48, v18, v17
v_fmac_f32 v41, v19, v16
v_fmac_f32 v49, v19, v17
v_lshlrev_b32 v18, 16, v149
v_and_b32 v19, 0xffff0000, v149
v_fmac_f32 v42, v18, v16
v_fmac_f32 v50, v18, v17
v_fmac_f32 v43, v19, v16
v_fmac_f32 v51, v19, v17
v_lshlrev_b32 v18, 16, v150
v_and_b32 v19, 0xffff0000, v150
v_fmac_f32 v44, v18, v16
v_fmac_f32 v52, v18, v17
v_fmac_f32 v45, v19, v16
v_fmac_f32 v53, v19, v17
v_lshlrev_b32 v18, 16, v151
v_and_b32 v19, 0xffff0000, v151
v_fmac_f32 v46, v18, v16
v_fmac_f32 v54, v18, v17
v_fmac_f32 v47, v19, v16
v_fmac_f32 v55, v19, v17
ds_read_b64 v[16:17], v12 offset:384
s_waitcnt vmcnt(25) lgkmcnt(0)
v_lshlrev_b32 v18, 16, v152
v_and_b32 v19, 0xffff0000, v152
v_fmac_f32 v40, v18, v16
v_fmac_f32 v48, v18, v17
v_fmac_f32 v41, v19, v16
v_fmac_f32 v49, v19, v17
v_lshlrev_b32 v18, 16, v153
v_and_b32 v19, 0xffff0000, v153
v_fmac_f32 v42, v18, v16
v_fmac_f32 v50, v18, v17
v_fmac_f32 v43, v19, v16
v_fmac_f32 v51, v19, v17
v_lshlrev_b32 v18, 16, v154
v_and_b32 v19, 0xffff0000, v154
v_fmac_f32 v44, v18, v16
v_fmac_f32 v52, v18, v17
v_fmac_f32 v45, v19, v16
v_fmac_f32 v53, v19, v17
v_lshlrev_b32 v18, 16, v155
v_and_b32 v19, 0xffff0000, v155
v_fmac_f32 v46, v18, v16
v_fmac_f32 v54, v18, v17
v_fmac_f32 v47, v19, v16
v_fmac_f32 v55, v19, v17
ds_read_b64 v[16:17], v12 offset:448
s_waitcnt vmcnt(24) lgkmcnt(0)
v_lshlrev_b32 v18, 16, v156
v_and_b32 v19, 0xffff0000, v156
v_fmac_f32 v40, v18, v16
v_fmac_f32 v48, v18, v17
v_fmac_f32 v41, v19, v16
v_fmac_f32 v49, v19, v17
v_lshlrev_b32 v18, 16, v157
v_and_b32 v19, 0xffff0000, v157
v_fmac_f32 v42, v18, v16
v_fmac_f32 v50, v18, v17
v_fmac_f32 v43, v19, v16
v_fmac_f32 v51, v19, v17
v_lshlrev_b32 v18, 16, v158
v_and_b32 v19, 0xffff0000, v158
v_fmac_f32 v44, v18, v16
v_fmac_f32 v52, v18, v17
v_fmac_f32 v45, v19, v16
v_fmac_f32 v53, v19, v17
v_lshlrev_b32 v18, 16, v159
v_and_b32 v19, 0xffff0000, v159
v_fmac_f32 v46, v18, v16
v_fmac_f32 v54, v18, v17
v_fmac_f32 v47, v19, v16
v_fmac_f32 v55, v19, v17
ds_read_b64 v[16:17], v12 offset:512
s_waitcnt vmcnt(23) lgkmcnt(0)
v_lshlrev_b32 v18, 16, v160
v_and_b32 v19, 0xffff0000, v160
v_fmac_f32 v40, v18, v16
v_fmac_f32 v48, v18, v17
v_fmac_f32 v41, v19, v16
v_fmac_f32 v49, v19, v17
v_lshlrev_b32 v18, 16, v161
v_and_b32 v19, 0xffff0000, v161
v_fmac_f32 v42, v18, v16
v_fmac_f32 v50, v18, v17
v_fmac_f32 v43, v19, v16
v_fmac_f32 v51, v19, v17
v_lshlrev_b32 v18, 16, v162
v_and_b32 v19, 0xffff0000, v162
v_fmac_f32 v44, v18, v16
v_fmac_f32 v52, v18, v17
v_fmac_f32 v45, v19, v16
v_fmac_f32 v53, v19, v17
v_lshlrev_b32 v18, 16, v163
v_and_b32 v19, 0xffff0000, v163
v_fmac_f32 v46, v18, v16
v_fmac_f32 v54, v18, v17
v_fmac_f32 v47, v19, v16
v_fmac_f32 v55, v19, v17
ds_read_b64 v[16:17], v12 offset:576
s_waitcnt vmcnt(22) lgkmcnt(0)
v_lshlrev_b32 v18, 16, v164
v_and_b32 v19, 0xffff0000, v164
v_fmac_f32 v40, v18, v16
v_fmac_f32 v48, v18, v17
v_fmac_f32 v41, v19, v16
v_fmac_f32 v49, v19, v17
v_lshlrev_b32 v18, 16, v165
v_and_b32 v19, 0xffff0000, v165
v_fmac_f32 v42, v18, v16
v_fmac_f32 v50, v18, v17
v_fmac_f32 v43, v19, v16
v_fmac_f32 v51, v19, v17
v_lshlrev_b32 v18, 16, v166
v_and_b32 v19, 0xffff0000, v166
v_fmac_f32 v44, v18, v16
v_fmac_f32 v52, v18, v17
v_fmac_f32 v45, v19, v16
v_fmac_f32 v53, v19, v17
v_lshlrev_b32 v18, 16, v167
v_and_b32 v19, 0xffff0000, v167
v_fmac_f32 v46, v18, v16
v_fmac_f32 v54, v18, v17
v_fmac_f32 v47, v19, v16
v_fmac_f32 v55, v19, v17
ds_read_b64 v[16:17], v12 offset:640
s_waitcnt vmcnt(21) lgkmcnt(0)
v_lshlrev_b32 v18, 16, v168
v_and_b32 v19, 0xffff0000, v168
v_fmac_f32 v40, v18, v16
v_fmac_f32 v48, v18, v17
v_fmac_f32 v41, v19, v16
v_fmac_f32 v49, v19, v17
v_lshlrev_b32 v18, 16, v169
v_and_b32 v19, 0xffff0000, v169
v_fmac_f32 v42, v18, v16
v_fmac_f32 v50, v18, v17
v_fmac_f32 v43, v19, v16
v_fmac_f32 v51, v19, v17
v_lshlrev_b32 v18, 16, v170
v_and_b32 v19, 0xffff0000, v170
v_fmac_f32 v44, v18, v16
v_fmac_f32 v52, v18, v17
v_fmac_f32 v45, v19, v16
v_fmac_f32 v53, v19, v17
v_lshlrev_b32 v18, 16, v171
v_and_b32 v19, 0xffff0000, v171
v_fmac_f32 v46, v18, v16
v_fmac_f32 v54, v18, v17
v_fmac_f32 v47, v19, v16
v_fmac_f32 v55, v19, v17
ds_read_b64 v[16:17], v12 offset:704
s_waitcnt vmcnt(20) lgkmcnt(0)
v_lshlrev_b32 v18, 16, v172
v_and_b32 v19, 0xffff0000, v172
v_fmac_f32 v40, v18, v16
v_fmac_f32 v48, v18, v17
v_fmac_f32 v41, v19, v16
v_fmac_f32 v49, v19, v17
v_lshlrev_b32 v18, 16, v173
v_and_b32 v19, 0xffff0000, v173
v_fmac_f32 v42, v18, v16
v_fmac_f32 v50, v18, v17
v_fmac_f32 v43, v19, v16
v_fmac_f32 v51, v19, v17
v_lshlrev_b32 v18, 16, v174
v_and_b32 v19, 0xffff0000, v174
v_fmac_f32 v44, v18, v16
v_fmac_f32 v52, v18, v17
v_fmac_f32 v45, v19, v16
v_fmac_f32 v53, v19, v17
v_lshlrev_b32 v18, 16, v175
v_and_b32 v19, 0xffff0000, v175
v_fmac_f32 v46, v18, v16
v_fmac_f32 v54, v18, v17
v_fmac_f32 v47, v19, v16
v_fmac_f32 v55, v19, v17
ds_read_b64 v[16:17], v12 offset:768
s_waitcnt vmcnt(19) lgkmcnt(0)
v_lshlrev_b32 v18, 16, v176
v_and_b32 v19, 0xffff0000, v176
v_fmac_f32 v40, v18, v16
v_fmac_f32 v48, v18, v17
v_fmac_f32 v41, v19, v16
v_fmac_f32 v49, v19, v17
v_lshlrev_b32 v18, 16, v177
v_and_b32 v19, 0xffff0000, v177
v_fmac_f32 v42, v18, v16
v_fmac_f32 v50, v18, v17
v_fmac_f32 v43, v19, v16
v_fmac_f32 v51, v19, v17
v_lshlrev_b32 v18, 16, v178
v_and_b32 v19, 0xffff0000, v178
v_fmac_f32 v44, v18, v16
v_fmac_f32 v52, v18, v17
v_fmac_f32 v45, v19, v16
v_fmac_f32 v53, v19, v17
v_lshlrev_b32 v18, 16, v179
v_and_b32 v19, 0xffff0000, v179
v_fmac_f32 v46, v18, v16
v_fmac_f32 v54, v18, v17
v_fmac_f32 v47, v19, v16
v_fmac_f32 v55, v19, v17
ds_read_b64 v[16:17], v12 offset:832
s_waitcnt vmcnt(18) lgkmcnt(0)
v_lshlrev_b32 v18, 16, v180
v_and_b32 v19, 0xffff0000, v180
v_fmac_f32 v40, v18, v16
v_fmac_f32 v48, v18, v17
v_fmac_f32 v41, v19, v16
v_fmac_f32 v49, v19, v17
v_lshlrev_b32 v18, 16, v181
v_and_b32 v19, 0xffff0000, v181
v_fmac_f32 v42, v18, v16
v_fmac_f32 v50, v18, v17
v_fmac_f32 v43, v19, v16
v_fmac_f32 v51, v19, v17
v_lshlrev_b32 v18, 16, v182
v_and_b32 v19, 0xffff0000, v182
v_fmac_f32 v44, v18, v16
v_fmac_f32 v52, v18, v17
v_fmac_f32 v45, v19, v16
v_fmac_f32 v53, v19, v17
v_lshlrev_b32 v18, 16, v183
v_and_b32 v19, 0xffff0000, v183
v_fmac_f32 v46, v18, v16
v_fmac_f32 v54, v18, v17
v_fmac_f32 v47, v19, v16
v_fmac_f32 v55, v19, v17
ds_read_b64 v[16:17], v12 offset:896
s_waitcnt vmcnt(17) lgkmcnt(0)
v_lshlrev_b32 v18, 16, v184
v_and_b32 v19, 0xffff0000, v184
v_fmac_f32 v40, v18, v16
v_fmac_f32 v48, v18, v17
v_fmac_f32 v41, v19, v16
v_fmac_f32 v49, v19, v17
v_lshlrev_b32 v18, 16, v185
v_and_b32 v19, 0xffff0000, v185
v_fmac_f32 v42, v18, v16
v_fmac_f32 v50, v18, v17
v_fmac_f32 v43, v19, v16
v_fmac_f32 v51, v19, v17
v_lshlrev_b32 v18, 16, v186
v_and_b32 v19, 0xffff0000, v186
v_fmac_f32 v44, v18, v16
v_fmac_f32 v52, v18, v17
v_fmac_f32 v45, v19, v16
v_fmac_f32 v53, v19, v17
v_lshlrev_b32 v18, 16, v187
v_and_b32 v19, 0xffff0000, v187
v_fmac_f32 v46, v18, v16
v_fmac_f32 v54, v18, v17
v_fmac_f32 v47, v19, v16
v_fmac_f32 v55, v19, v17
ds_read_b64 v[16:17], v12 offset:960
s_waitcnt vmcnt(16) lgkmcnt(0)
v_lshlrev_b32 v18, 16, v188
v_and_b32 v19, 0xffff0000, v188
v_fmac_f32 v40, v18, v16
v_fmac_f32 v48, v18, v17
v_fmac_f32 v41, v19, v16
v_fmac_f32 v49, v19, v17
v_lshlrev_b32 v18, 16, v189
v_and_b32 v19, 0xffff0000, v189
v_fmac_f32 v42, v18, v16
v_fmac_f32 v50, v18, v17
v_fmac_f32 v43, v19, v16
v_fmac_f32 v51, v19, v17
v_lshlrev_b32 v18, 16, v190
v_and_b32 v19, 0xffff0000, v190
v_fmac_f32 v44, v18, v16
v_fmac_f32 v52, v18, v17
v_fmac_f32 v45, v19, v16
v_fmac_f32 v53, v19, v17
v_lshlrev_b32 v18, 16, v191
v_and_b32 v19, 0xffff0000, v191
v_fmac_f32 v46, v18, v16
v_fmac_f32 v54, v18, v17
v_fmac_f32 v47, v19, v16
v_fmac_f32 v55, v19, v17
ds_read_b64 v[16:17], v12 offset:1024
s_waitcnt vmcnt(15) lgkmcnt(0)
v_lshlrev_b32 v18, 16, v192
v_and_b32 v19, 0xffff0000, v192
v_fmac_f32 v40, v18, v16
v_fmac_f32 v48, v18, v17
v_fmac_f32 v41, v19, v16
v_fmac_f32 v49, v19, v17
v_lshlrev_b32 v18, 16, v193
v_and_b32 v19, 0xffff0000, v193
v_fmac_f32 v42, v18, v16
v_fmac_f32 v50, v18, v17
v_fmac_f32 v43, v19, v16
v_fmac_f32 v51, v19, v17
v_lshlrev_b32 v18, 16, v194
v_and_b32 v19, 0xffff0000, v194
v_fmac_f32 v44, v18, v16
v_fmac_f32 v52, v18, v17
v_fmac_f32 v45, v19, v16
v_fmac_f32 v53, v19, v17
v_lshlrev_b32 v18, 16, v195
v_and_b32 v19, 0xffff0000, v195
v_fmac_f32 v46, v18, v16
v_fmac_f32 v54, v18, v17
v_fmac_f32 v47, v19, v16
v_fmac_f32 v55, v19, v17
ds_read_b64 v[16:17], v12 offset:1088
s_waitcnt vmcnt(14) lgkmcnt(0)
v_lshlrev_b32 v18, 16, v196
v_and_b32 v19, 0xffff0000, v196
v_fmac_f32 v40, v18, v16
v_fmac_f32 v48, v18, v17
v_fmac_f32 v41, v19, v16
v_fmac_f32 v49, v19, v17
v_lshlrev_b32 v18, 16, v197
v_and_b32 v19, 0xffff0000, v197
v_fmac_f32 v42, v18, v16
v_fmac_f32 v50, v18, v17
v_fmac_f32 v43, v19, v16
v_fmac_f32 v51, v19, v17
v_lshlrev_b32 v18, 16, v198
v_and_b32 v19, 0xffff0000, v198
v_fmac_f32 v44, v18, v16
v_fmac_f32 v52, v18, v17
v_fmac_f32 v45, v19, v16
v_fmac_f32 v53, v19, v17
v_lshlrev_b32 v18, 16, v199
v_and_b32 v19, 0xffff0000, v199
v_fmac_f32 v46, v18, v16
v_fmac_f32 v54, v18, v17
v_fmac_f32 v47, v19, v16
v_fmac_f32 v55, v19, v17
ds_read_b64 v[16:17], v12 offset:1152
s_waitcnt vmcnt(13) lgkmcnt(0)
v_lshlrev_b32 v18, 16, v200
v_and_b32 v19, 0xffff0000, v200
v_fmac_f32 v40, v18, v16
v_fmac_f32 v48, v18, v17
v_fmac_f32 v41, v19, v16
v_fmac_f32 v49, v19, v17
v_lshlrev_b32 v18, 16, v201
v_and_b32 v19, 0xffff0000, v201
v_fmac_f32 v42, v18, v16
v_fmac_f32 v50, v18, v17
v_fmac_f32 v43, v19, v16
v_fmac_f32 v51, v19, v17
v_lshlrev_b32 v18, 16, v202
v_and_b32 v19, 0xffff0000, v202
v_fmac_f32 v44, v18, v16
v_fmac_f32 v52, v18, v17
v_fmac_f32 v45, v19, v16
v_fmac_f32 v53, v19, v17
v_lshlrev_b32 v18, 16, v203
v_and_b32 v19, 0xffff0000, v203
v_fmac_f32 v46, v18, v16
v_fmac_f32 v54, v18, v17
v_fmac_f32 v47, v19, v16
v_fmac_f32 v55, v19, v17
ds_read_b64 v[16:17], v12 offset:1216
s_waitcnt vmcnt(12) lgkmcnt(0)
v_lshlrev_b32 v18, 16, v204
v_and_b32 v19, 0xffff0000, v204
v_fmac_f32 v40, v18, v16
v_fmac_f32 v48, v18, v17
v_fmac_f32 v41, v19, v16
v_fmac_f32 v49, v19, v17
v_lshlrev_b32 v18, 16, v205
v_and_b32 v19, 0xffff0000, v205
v_fmac_f32 v42, v18, v16
v_fmac_f32 v50, v18, v17
v_fmac_f32 v43, v19, v16
v_fmac_f32 v51, v19, v17
v_lshlrev_b32 v18, 16, v206
v_and_b32 v19, 0xffff0000, v206
v_fmac_f32 v44, v18, v16
v_fmac_f32 v52, v18, v17
v_fmac_f32 v45, v19, v16
v_fmac_f32 v53, v19, v17
v_lshlrev_b32 v18, 16, v207
v_and_b32 v19, 0xffff0000, v207
v_fmac_f32 v46, v18, v16
v_fmac_f32 v54, v18, v17
v_fmac_f32 v47, v19, v16
v_fmac_f32 v55, v19, v17
ds_read_b64 v[16:17], v12 offset:1280
s_waitcnt vmcnt(11) lgkmcnt(0)
v_lshlrev_b32 v18, 16, v208
v_and_b32 v19, 0xffff0000, v208
v_fmac_f32 v40, v18, v16
v_fmac_f32 v48, v18, v17
v_fmac_f32 v41, v19, v16
v_fmac_f32 v49, v19, v17
v_lshlrev_b32 v18, 16, v209
v_and_b32 v19, 0xffff0000, v209
v_fmac_f32 v42, v18, v16
v_fmac_f32 v50, v18, v17
v_fmac_f32 v43, v19, v16
v_fmac_f32 v51, v19, v17
v_lshlrev_b32 v18, 16, v210
v_and_b32 v19, 0xffff0000, v210
v_fmac_f32 v44, v18, v16
v_fmac_f32 v52, v18, v17
v_fmac_f32 v45, v19, v16
v_fmac_f32 v53, v19, v17
v_lshlrev_b32 v18, 16, v211
v_and_b32 v19, 0xffff0000, v211
v_fmac_f32 v46, v18, v16
v_fmac_f32 v54, v18, v17
v_fmac_f32 v47, v19, v16
v_fmac_f32 v55, v19, v17
ds_read_b64 v[16:17], v12 offset:1344
s_waitcnt vmcnt(10) lgkmcnt(0)
v_lshlrev_b32 v18, 16, v212
v_and_b32 v19, 0xffff0000, v212
v_fmac_f32 v40, v18, v16
v_fmac_f32 v48, v18, v17
v_fmac_f32 v41, v19, v16
v_fmac_f32 v49, v19, v17
v_lshlrev_b32 v18, 16, v213
v_and_b32 v19, 0xffff0000, v213
v_fmac_f32 v42, v18, v16
v_fmac_f32 v50, v18, v17
v_fmac_f32 v43, v19, v16
v_fmac_f32 v51, v19, v17
v_lshlrev_b32 v18, 16, v214
v_and_b32 v19, 0xffff0000, v214
v_fmac_f32 v44, v18, v16
v_fmac_f32 v52, v18, v17
v_fmac_f32 v45, v19, v16
v_fmac_f32 v53, v19, v17
v_lshlrev_b32 v18, 16, v215
v_and_b32 v19, 0xffff0000, v215
v_fmac_f32 v46, v18, v16
v_fmac_f32 v54, v18, v17
v_fmac_f32 v47, v19, v16
v_fmac_f32 v55, v19, v17
ds_read_b64 v[16:17], v12 offset:1408
s_waitcnt vmcnt(9) lgkmcnt(0)
v_lshlrev_b32 v18, 16, v216
v_and_b32 v19, 0xffff0000, v216
v_fmac_f32 v40, v18, v16
v_fmac_f32 v48, v18, v17
v_fmac_f32 v41, v19, v16
v_fmac_f32 v49, v19, v17
v_lshlrev_b32 v18, 16, v217
v_and_b32 v19, 0xffff0000, v217
v_fmac_f32 v42, v18, v16
v_fmac_f32 v50, v18, v17
v_fmac_f32 v43, v19, v16
v_fmac_f32 v51, v19, v17
v_lshlrev_b32 v18, 16, v218
v_and_b32 v19, 0xffff0000, v218
v_fmac_f32 v44, v18, v16
v_fmac_f32 v52, v18, v17
v_fmac_f32 v45, v19, v16
v_fmac_f32 v53, v19, v17
v_lshlrev_b32 v18, 16, v219
v_and_b32 v19, 0xffff0000, v219
v_fmac_f32 v46, v18, v16
v_fmac_f32 v54, v18, v17
v_fmac_f32 v47, v19, v16
v_fmac_f32 v55, v19, v17
ds_read_b64 v[16:17], v12 offset:1472
s_waitcnt vmcnt(8) lgkmcnt(0)
v_lshlrev_b32 v18, 16, v220
v_and_b32 v19, 0xffff0000, v220
v_fmac_f32 v40, v18, v16
v_fmac_f32 v48, v18, v17
v_fmac_f32 v41, v19, v16
v_fmac_f32 v49, v19, v17
v_lshlrev_b32 v18, 16, v221
v_and_b32 v19, 0xffff0000, v221
v_fmac_f32 v42, v18, v16
v_fmac_f32 v50, v18, v17
v_fmac_f32 v43, v19, v16
v_fmac_f32 v51, v19, v17
v_lshlrev_b32 v18, 16, v222
v_and_b32 v19, 0xffff0000, v222
v_fmac_f32 v44, v18, v16
v_fmac_f32 v52, v18, v17
v_fmac_f32 v45, v19, v16
v_fmac_f32 v53, v19, v17
v_lshlrev_b32 v18, 16, v223
v_and_b32 v19, 0xffff0000, v223
v_fmac_f32 v46, v18, v16
v_fmac_f32 v54, v18, v17
v_fmac_f32 v47, v19, v16
v_fmac_f32 v55, v19, v17
ds_read_b64 v[16:17], v12 offset:1536
s_waitcnt vmcnt(7) lgkmcnt(0)
v_lshlrev_b32 v18, 16, v224
v_and_b32 v19, 0xffff0000, v224
v_fmac_f32 v40, v18, v16
v_fmac_f32 v48, v18, v17
v_fmac_f32 v41, v19, v16
v_fmac_f32 v49, v19, v17
v_lshlrev_b32 v18, 16, v225
v_and_b32 v19, 0xffff0000, v225
v_fmac_f32 v42, v18, v16
v_fmac_f32 v50, v18, v17
v_fmac_f32 v43, v19, v16
v_fmac_f32 v51, v19, v17
v_lshlrev_b32 v18, 16, v226
v_and_b32 v19, 0xffff0000, v226
v_fmac_f32 v44, v18, v16
v_fmac_f32 v52, v18, v17
v_fmac_f32 v45, v19, v16
v_fmac_f32 v53, v19, v17
v_lshlrev_b32 v18, 16, v227
v_and_b32 v19, 0xffff0000, v227
v_fmac_f32 v46, v18, v16
v_fmac_f32 v54, v18, v17
v_fmac_f32 v47, v19, v16
v_fmac_f32 v55, v19, v17
ds_read_b64 v[16:17], v12 offset:1600
s_waitcnt vmcnt(6) lgkmcnt(0)
v_lshlrev_b32 v18, 16, v228
v_and_b32 v19, 0xffff0000, v228
v_fmac_f32 v40, v18, v16
v_fmac_f32 v48, v18, v17
v_fmac_f32 v41, v19, v16
v_fmac_f32 v49, v19, v17
v_lshlrev_b32 v18, 16, v229
v_and_b32 v19, 0xffff0000, v229
v_fmac_f32 v42, v18, v16
v_fmac_f32 v50, v18, v17
v_fmac_f32 v43, v19, v16
v_fmac_f32 v51, v19, v17
v_lshlrev_b32 v18, 16, v230
v_and_b32 v19, 0xffff0000, v230
v_fmac_f32 v44, v18, v16
v_fmac_f32 v52, v18, v17
v_fmac_f32 v45, v19, v16
v_fmac_f32 v53, v19, v17
v_lshlrev_b32 v18, 16, v231
v_and_b32 v19, 0xffff0000, v231
v_fmac_f32 v46, v18, v16
v_fmac_f32 v54, v18, v17
v_fmac_f32 v47, v19, v16
v_fmac_f32 v55, v19, v17
ds_read_b64 v[16:17], v12 offset:1664
s_waitcnt vmcnt(5) lgkmcnt(0)
v_lshlrev_b32 v18, 16, v232
v_and_b32 v19, 0xffff0000, v232
v_fmac_f32 v40, v18, v16
v_fmac_f32 v48, v18, v17
v_fmac_f32 v41, v19, v16
v_fmac_f32 v49, v19, v17
v_lshlrev_b32 v18, 16, v233
v_and_b32 v19, 0xffff0000, v233
v_fmac_f32 v42, v18, v16
v_fmac_f32 v50, v18, v17
v_fmac_f32 v43, v19, v16
v_fmac_f32 v51, v19, v17
v_lshlrev_b32 v18, 16, v234
v_and_b32 v19, 0xffff0000, v234
v_fmac_f32 v44, v18, v16
v_fmac_f32 v52, v18, v17
v_fmac_f32 v45, v19, v16
v_fmac_f32 v53, v19, v17
v_lshlrev_b32 v18, 16, v235
v_and_b32 v19, 0xffff0000, v235
v_fmac_f32 v46, v18, v16
v_fmac_f32 v54, v18, v17
v_fmac_f32 v47, v19, v16
v_fmac_f32 v55, v19, v17
ds_read_b64 v[16:17], v12 offset:1728
s_waitcnt vmcnt(4) lgkmcnt(0)
v_lshlrev_b32 v18, 16, v236
v_and_b32 v19, 0xffff0000, v236
v_fmac_f32 v40, v18, v16
v_fmac_f32 v48, v18, v17
v_fmac_f32 v41, v19, v16
v_fmac_f32 v49, v19, v17
v_lshlrev_b32 v18, 16, v237
v_and_b32 v19, 0xffff0000, v237
v_fmac_f32 v42, v18, v16
v_fmac_f32 v50, v18, v17
v_fmac_f32 v43, v19, v16
v_fmac_f32 v51, v19, v17
v_lshlrev_b32 v18, 16, v238
v_and_b32 v19, 0xffff0000, v238
v_fmac_f32 v44, v18, v16
v_fmac_f32 v52, v18, v17
v_fmac_f32 v45, v19, v16
v_fmac_f32 v53, v19, v17
v_lshlrev_b32 v18, 16, v239
v_and_b32 v19, 0xffff0000, v239
v_fmac_f32 v46, v18, v16
v_fmac_f32 v54, v18, v17
v_fmac_f32 v47, v19, v16
v_fmac_f32 v55, v19, v17
ds_read_b64 v[16:17], v12 offset:1792
s_waitcnt vmcnt(3) lgkmcnt(0)
v_lshlrev_b32 v18, 16, v240
v_and_b32 v19, 0xffff0000, v240
v_fmac_f32 v40, v18, v16
v_fmac_f32 v48, v18, v17
v_fmac_f32 v41, v19, v16
v_fmac_f32 v49, v19, v17
v_lshlrev_b32 v18, 16, v241
v_and_b32 v19, 0xffff0000, v241
v_fmac_f32 v42, v18, v16
v_fmac_f32 v50, v18, v17
v_fmac_f32 v43, v19, v16
v_fmac_f32 v51, v19, v17
v_lshlrev_b32 v18, 16, v242
v_and_b32 v19, 0xffff0000, v242
v_fmac_f32 v44, v18, v16
v_fmac_f32 v52, v18, v17
v_fmac_f32 v45, v19, v16
v_fmac_f32 v53, v19, v17
v_lshlrev_b32 v18, 16, v243
v_and_b32 v19, 0xffff0000, v243
v_fmac_f32 v46, v18, v16
v_fmac_f32 v54, v18, v17
v_fmac_f32 v47, v19, v16
v_fmac_f32 v55, v19, v17
ds_read_b64 v[16:17], v12 offset:1856
s_waitcnt vmcnt(2) lgkmcnt(0)
v_lshlrev_b32 v18, 16, v244
v_and_b32 v19, 0xffff0000, v244
v_fmac_f32 v40, v18, v16
v_fmac_f32 v48, v18, v17
v_fmac_f32 v41, v19, v16
v_fmac_f32 v49, v19, v17
v_lshlrev_b32 v18, 16, v245
v_and_b32 v19, 0xffff0000, v245
v_fmac_f32 v42, v18, v16
v_fmac_f32 v50, v18, v17
v_fmac_f32 v43, v19, v16
v_fmac_f32 v51, v19, v17
v_lshlrev_b32 v18, 16, v246
v_and_b32 v19, 0xffff0000, v246
v_fmac_f32 v44, v18, v16
v_fmac_f32 v52, v18, v17
v_fmac_f32 v45, v19, v16
v_fmac_f32 v53, v19, v17
v_lshlrev_b32 v18, 16, v247
v_and_b32 v19, 0xffff0000, v247
v_fmac_f32 v46, v18, v16
v_fmac_f32 v54, v18, v17
v_fmac_f32 v47, v19, v16
v_fmac_f32 v55, v19, v17
ds_read_b64 v[16:17], v12 offset:1920
s_waitcnt vmcnt(1) lgkmcnt(0)
v_lshlrev_b32 v18, 16, v248
v_and_b32 v19, 0xffff0000, v248
v_fmac_f32 v40, v18, v16
v_fmac_f32 v48, v18, v17
v_fmac_f32 v41, v19, v16
v_fmac_f32 v49, v19, v17
v_lshlrev_b32 v18, 16, v249
v_and_b32 v19, 0xffff0000, v249
v_fmac_f32 v42, v18, v16
v_fmac_f32 v50, v18, v17
v_fmac_f32 v43, v19, v16
v_fmac_f32 v51, v19, v17
v_lshlrev_b32 v18, 16, v250
v_and_b32 v19, 0xffff0000, v250
v_fmac_f32 v44, v18, v16
v_fmac_f32 v52, v18, v17
v_fmac_f32 v45, v19, v16
v_fmac_f32 v53, v19, v17
v_lshlrev_b32 v18, 16, v251
v_and_b32 v19, 0xffff0000, v251
v_fmac_f32 v46, v18, v16
v_fmac_f32 v54, v18, v17
v_fmac_f32 v47, v19, v16
v_fmac_f32 v55, v19, v17
ds_read_b64 v[16:17], v12 offset:1984
s_waitcnt vmcnt(0) lgkmcnt(0)
v_lshlrev_b32 v18, 16, v252
v_and_b32 v19, 0xffff0000, v252
v_fmac_f32 v40, v18, v16
v_fmac_f32 v48, v18, v17
v_fmac_f32 v41, v19, v16
v_fmac_f32 v49, v19, v17
v_lshlrev_b32 v18, 16, v253
v_and_b32 v19, 0xffff0000, v253
v_fmac_f32 v42, v18, v16
v_fmac_f32 v50, v18, v17
v_fmac_f32 v43, v19, v16
v_fmac_f32 v51, v19, v17
v_lshlrev_b32 v18, 16, v254
v_and_b32 v19, 0xffff0000, v254
v_fmac_f32 v44, v18, v16
v_fmac_f32 v52, v18, v17
v_fmac_f32 v45, v19, v16
v_fmac_f32 v53, v19, v17
v_lshlrev_b32 v18, 16, v255
v_and_b32 v19, 0xffff0000, v255
v_fmac_f32 v46, v18, v16
v_fmac_f32 v54, v18, v17
v_fmac_f32 v47, v19, v16
v_fmac_f32 v55, v19, v17
v_mul_u32_u24 v12, 3584, v10
v_lshl_add_u32 v12, v9, 5, v12
v_add_u32 v12, 4096, v12
v_cmp_gt_u32 vcc, 448, v0
s_and_saveexec_b64 s[12:13], vcc
ds_write_b128 v12, v[40:43]
ds_write_b128 v12, v[44:47] offset:16
ds_write_b128 v12, v[48:51] offset:1792
ds_write_b128 v12, v[52:55] offset:1808
s_mov_b64 exec, s[12:13]
s_waitcnt lgkmcnt(0)
s_barrier
s_mul_i32 s6, s2, 3584
s_add_u32 s6, s6, 16777216
v_add_u32 v12, 0, v0
v_lshlrev_b32 v12, 2, v12
v_mov_b32 v13, 0
ds_read_b32 v20, v12 offset:4096
ds_read_b32 v21, v12 offset:7680
ds_read_b32 v22, v12 offset:11264
ds_read_b32 v23, v12 offset:14848
ds_read_b32 v24, v12 offset:18432
ds_read_b32 v25, v12 offset:22016
ds_read_b32 v26, v12 offset:25600
ds_read_b32 v27, v12 offset:29184
s_waitcnt lgkmcnt(0)
v_add_f32 v13, v13, v20
v_add_f32 v13, v13, v21
v_add_f32 v13, v13, v22
v_add_f32 v13, v13, v23
v_add_f32 v13, v13, v24
v_add_f32 v13, v13, v25
v_add_f32 v13, v13, v26
v_add_f32 v13, v13, v27
v_add_u32 v12, s6, v12
v_cmp_gt_u32 vcc, 512, v0
s_and_saveexec_b64 s[12:13], vcc
global_store_dword v12, v13, s[40:41]
s_mov_b64 exec, s[12:13]
v_add_u32 v12, 512, v0
v_lshlrev_b32 v12, 2, v12
v_mov_b32 v13, 0
ds_read_b32 v20, v12 offset:4096
ds_read_b32 v21, v12 offset:7680
ds_read_b32 v22, v12 offset:11264
ds_read_b32 v23, v12 offset:14848
ds_read_b32 v24, v12 offset:18432
ds_read_b32 v25, v12 offset:22016
ds_read_b32 v26, v12 offset:25600
ds_read_b32 v27, v12 offset:29184
s_waitcnt lgkmcnt(0)
v_add_f32 v13, v13, v20
v_add_f32 v13, v13, v21
v_add_f32 v13, v13, v22
v_add_f32 v13, v13, v23
v_add_f32 v13, v13, v24
v_add_f32 v13, v13, v25
v_add_f32 v13, v13, v26
v_add_f32 v13, v13, v27
v_add_u32 v12, s6, v12
v_cmp_gt_u32 vcc, 384, v0
s_and_saveexec_b64 s[12:13], vcc
global_store_dword v12, v13, s[40:41]
s_mov_b64 exec, s[12:13]
kc_kernel_end:
s_endpgm
.section .rodata,"a"
.p2align 6
.amdhsa_kernel kc_kernel
  .amdhsa_next_free_vgpr 256
  .amdhsa_next_free_sgpr 96
  .amdhsa_accum_offset 256
  .amdhsa_group_segment_fixed_size 0
  .amdhsa_kernarg_size 112
  .amdhsa_user_sgpr_count 2
  .amdhsa_user_sgpr_kernarg_segment_ptr 1
  .amdhsa_system_sgpr_workgroup_id_x 1
.end_amdhsa_kernel
.text
.globl kd_kernel
.p2align 8
.type kd_kernel,@function
kd_kernel:
s_cmp_ge_u32 s2, 28
s_cbranch_scc1 kd_kernel_end
s_load_dwordx16 s[16:31], s[0:1], 0
s_load_dwordx8 s[32:39], s[0:1], 64
s_load_dwordx2 s[40:41], s[0:1], 104
s_waitcnt lgkmcnt(0)
v_and_b32 v3, 31, v0
v_lshrrev_b32 v4, 5, v0
s_lshl_b32 s4, s2, 5
v_add_u32 v3, s4, v3
v_mul_u32_u24 v5, 3584, v4
v_lshl_add_u32 v5, v3, 2, v5
v_add_u32 v5, 16777216, v5
v_mov_b32 v99, 0
global_load_dword v64, v5, s[40:41]
v_add_u32 v5, 28672, v5
global_load_dword v65, v5, s[40:41]
v_add_u32 v5, 28672, v5
global_load_dword v66, v5, s[40:41]
v_add_u32 v5, 28672, v5
global_load_dword v67, v5, s[40:41]
v_add_u32 v5, 28672, v5
global_load_dword v68, v5, s[40:41]
v_add_u32 v5, 28672, v5
global_load_dword v69, v5, s[40:41]
v_add_u32 v5, 28672, v5
global_load_dword v70, v5, s[40:41]
v_add_u32 v5, 28672, v5
global_load_dword v71, v5, s[40:41]
v_add_u32 v5, 28672, v5
global_load_dword v72, v5, s[40:41]
v_add_u32 v5, 28672, v5
global_load_dword v73, v5, s[40:41]
v_add_u32 v5, 28672, v5
global_load_dword v74, v5, s[40:41]
v_add_u32 v5, 28672, v5
global_load_dword v75, v5, s[40:41]
v_add_u32 v5, 28672, v5
global_load_dword v76, v5, s[40:41]
v_add_u32 v5, 28672, v5
global_load_dword v77, v5, s[40:41]
v_add_u32 v5, 28672, v5
global_load_dword v78, v5, s[40:41]
v_add_u32 v5, 28672, v5
global_load_dword v79, v5, s[40:41]
v_add_u32 v5, 28672, v5
global_load_dword v80, v5, s[40:41]
v_add_u32 v5, 28672, v5
global_load_dword v81, v5, s[40:41]
v_add_u32 v5, 28672, v5
global_load_dword v82, v5, s[40:41]
v_add_u32 v5, 28672, v5
global_load_dword v83, v5, s[40:41]
v_add_u32 v5, 28672, v5
global_load_dword v84, v5, s[40:41]
v_add_u32 v5, 28672, v5
global_load_dword v85, v5, s[40:41]
v_add_u32 v5, 28672, v5
global_load_dword v86, v5, s[40:41]
v_add_u32 v5, 28672, v5
global_load_dword v87, v5, s[40:41]
v_add_u32 v5, 28672, v5
global_load_dword v88, v5, s[40:41]
v_add_u32 v5, 28672, v5
global_load_dword v89, v5, s[40:41]
v_add_u32 v5, 28672, v5
global_load_dword v90, v5, s[40:41]
v_add_u32 v5, 28672, v5
global_load_dword v91, v5, s[40:41]
v_add_u32 v5, 28672, v5
global_load_dword v92, v5, s[40:41]
v_add_u32 v5, 28672, v5
global_load_dword v93, v5, s[40:41]
v_add_u32 v5, 28672, v5
global_load_dword v94, v5, s[40:41]
v_add_u32 v5, 28672, v5
global_load_dword v95, v5, s[40:41]
v_add_u32 v5, 28672, v5
global_load_dword v96, v5, s[40:41]
v_add_u32 v5, 28672, v5
global_load_dword v97, v5, s[40:41]
v_add_u32 v5, 28672, v5
global_load_dword v98, v5, s[40:41]
v_add_u32 v5, 28672, v5
v_cmp_gt_u32 vcc, 4, v4
s_and_saveexec_b64 s[12:13], vcc
global_load_dword v99, v5, s[40:41]
s_mov_b64 exec, s[12:13]
v_lshlrev_b32 v6, 1, v3
global_load_ushort v7, v6, s[16:17]
v_mul_u32_u24 v8, 1171, v3
v_lshrrev_b32 v8, 19, v8
v_mul_u32_u24 v8, 448, v8
v_sub_u32 v8, v3, v8
v_lshlrev_b32 v8, 1, v8
global_load_ushort v9, v8, s[36:37]
s_waitcnt vmcnt(0)
v_add_f32 v99, v99, v64
v_add_f32 v99, v99, v65
v_add_f32 v99, v99, v66
v_add_f32 v99, v99, v67
v_add_f32 v99, v99, v68
v_add_f32 v99, v99, v69
v_add_f32 v99, v99, v70
v_add_f32 v99, v99, v71
v_add_f32 v99, v99, v72
v_add_f32 v99, v99, v73
v_add_f32 v99, v99, v74
v_add_f32 v99, v99, v75
v_add_f32 v99, v99, v76
v_add_f32 v99, v99, v77
v_add_f32 v99, v99, v78
v_add_f32 v99, v99, v79
v_add_f32 v99, v99, v80
v_add_f32 v99, v99, v81
v_add_f32 v99, v99, v82
v_add_f32 v99, v99, v83
v_add_f32 v99, v99, v84
v_add_f32 v99, v99, v85
v_add_f32 v99, v99, v86
v_add_f32 v99, v99, v87
v_add_f32 v99, v99, v88
v_add_f32 v99, v99, v89
v_add_f32 v99, v99, v90
v_add_f32 v99, v99, v91
v_add_f32 v99, v99, v92
v_add_f32 v99, v99, v93
v_add_f32 v99, v99, v94
v_add_f32 v99, v99, v95
v_add_f32 v99, v99, v96
v_add_f32 v99, v99, v97
v_add_f32 v99, v99, v98
v_lshlrev_b32 v10, 2, v0
ds_write_b32 v10, v99
s_waitcnt lgkmcnt(0)
s_barrier
v_cmp_gt_u32 vcc, 32, v0
s_and_saveexec_b64 s[12:13], vcc
s_cbranch_execz kd_kernel_end
ds_read_b32 v20, v10 offset:0
ds_read_b32 v21, v10 offset:128
ds_read_b32 v22, v10 offset:256
ds_read_b32 v23, v10 offset:384
ds_read_b32 v24, v10 offset:512
ds_read_b32 v25, v10 offset:640
ds_read_b32 v26, v10 offset:768
ds_read_b32 v27, v10 offset:896
s_waitcnt lgkmcnt(0)
v_add_f32 v20, v20, v21
v_add_f32 v20, v20, v22
v_add_f32 v20, v20, v23
v_add_f32 v20, v20, v24
v_add_f32 v20, v20, v25
v_add_f32 v20, v20, v26
v_add_f32 v20, v20, v27
v_lshlrev_b32 v7, 16, v7
v_lshlrev_b32 v9, 16, v9
v_add_f32 v20, v20, v7
v_add_f32 v20, v20, v9
v_cvt_pk_bf16_f32 v20, v20, v20
global_store_short v6, v20, s[38:39]
kd_kernel_end:
s_endpgm
.section .rodata,"a"
.p2align 6
.amdhsa_kernel kd_kernel
  .amdhsa_next_free_vgpr 104
  .amdhsa_next_free_sgpr 96
  .amdhsa_accum_offset 104
  .amdhsa_group_segment_fixed_size 0
  .amdhsa_kernarg_size 112
  .amdhsa_user_sgpr_count 2
  .amdhsa_user_sgpr_kernarg_segment_ptr 1
  .amdhsa_system_sgpr_workgroup_id_x 1
.end_amdhsa_kernel
.text
```
